```python
import torch

def _softmax(x, axis=-1):
    return torch.softmax(x, dim=axis)
def _gelu(x):
    return torch.nn.functional.gelu(x, approximate="tanh")
def _silu(x):
    return torch.nn.functional.silu(x)
def _sigmoid(x):
    return torch.sigmoid(x)
def _layernorm(x, axis=-1, eps=1e-5):
    m = x.mean(dim=axis, keepdim=True)
    v = x.var(dim=axis, keepdim=True, unbiased=False)
    return (x - m) / torch.sqrt(v + eps)
def _scatter_add(tgt, idx, src, axis=0):
    return tgt.clone().index_add_(axis, idx, src)
def _segment_sum(src, seg, n):
    out = torch.zeros((n,) + src.shape[1:], dtype=src.dtype)
    return out.index_add_(0, seg, src)
def _pad(x, pw):
    flat = tuple(v for pair in reversed(pw) for v in pair)
    return torch.nn.functional.pad(x, flat)

kernel_name = 'gated_mix__mha_block__mixer_s_mlp__prompt'

def setup_inputs():

    _w = (lambda a: (lambda t: t.to(torch.bfloat16) if t.is_floating_point() else t)(torch.as_tensor(a)))
    def _A_setup():
        B, S, D, H = 1, 2048, 512, 32
        return {
            "x": _w((lambda *s: torch.randn(*s, dtype=torch.bfloat16) * 0.05)(B, S, D)),
            "wqkv": _w((lambda *s: torch.randn(*s, dtype=torch.bfloat16) * 1.6)(D, 3 * D)),
            "wo": _w((lambda *s: torch.randn(*s, dtype=torch.bfloat16) * 0.1)(D, D)),
        }
    _A_in = _A_setup()

    def _B_setup():
        B, S, D, F = 1, 2048, 512, 1792
        return {
            "x":  _w((lambda *s: torch.randn(*s, dtype=torch.bfloat16) * 0.05)(B, S, D)),
            "w1": _w((lambda *s: torch.randn(*s, dtype=torch.bfloat16) * 3.2)(D, D) * (D ** -0.5)),
            "w2": _w((lambda *s: torch.randn(*s, dtype=torch.bfloat16) * 3.2)(D, D) * (D ** -0.5)),
            "w3": _w((lambda *s: torch.randn(*s, dtype=torch.bfloat16) * 3.2)(D, F) * (D ** -0.5)),
            "w4": _w((lambda *s: torch.randn(*s, dtype=torch.bfloat16) * 1.6)(F, D) * (F ** -0.5)),
        }
    _B_in = _B_setup()

    return {
        "A_x": _A_in["x"],
        "A_wqkv": _A_in["wqkv"],
        "A_wo": _A_in["wo"],
        "B_x": _B_in["x"],
        "B_w1": _B_in["w1"],
        "B_w2": _B_in["w2"],
        "B_w3": _B_in["w3"],
        "B_w4": _B_in["w4"],
        "gate_w": _w((lambda *s: torch.randn(*s, dtype=torch.bfloat16) * 0.05)(512) * 16.0),
    }

def reference(A_x, A_wqkv, A_wo, B_x, B_w1, B_w2, B_w3, B_w4, gate_w):
    def _A_ref(x, wqkv, wo):
        B, S, D = x.shape
        H = 32
        Dh = D // H
        qkv = (lambda x, *d: x.permute(*d))((x @ wqkv).reshape(B, S, 3, H, Dh), 2, 0, 3, 1, 4)
        q, k, v = qkv[0], qkv[1], qkv[2]
        scores = torch.einsum("bhqd,bhkd->bhqk", q, k) * (Dh ** -0.5)
        p = _softmax(scores, axis=-1)
        o = torch.einsum("bhqk,bhkd->bhqd", p, v)
        return (lambda x, *d: x.permute(*d))(o, 0, 2, 1, 3).reshape(B, S, D) @ wo

    def _B_ref(x, w1, w2, w3, w4):
        B, S, D = x.shape
        h = _gelu(_layernorm(x, axis=-1) @ w1)
        c = D // 4
        g0 = _pad(h[:, :, 0*c:1*c], ((0, 0), (1, 0), (0, 0)))[:, :S, :]
        g1 = _pad(h[:, :, 1*c:2*c], ((0, 0), (0, 1), (0, 0)))[:, 1:, :]
        g2 = _pad(h[:, :, 2*c:3*c], ((0, 0), (2, 0), (0, 0)))[:, :S, :]
        g3 = _pad(h[:, :, 3*c:   ], ((0, 0), (0, 2), (0, 0)))[:, 2:, :]
        hs = torch.concatenate([g0, g1, g2, g3], axis=-1) @ w2
        x1 = x + hs
        h2 = _gelu(_layernorm(x1, axis=-1) @ w3) @ w4
        return x1 + h2

    x = A_x
    g = _sigmoid((x * gate_w).sum(-1, keepdims=True))
    a = _A_ref(x, A_wqkv, A_wo)
    b = _B_ref(x, B_w1, B_w2, B_w3, B_w4)
    return g * a + (1 - g) * b
```

```asm
; @launch kernel=g1_kernel grid=(256,1,1) block=(512,1,1) lds=163840
; @launch kernel=mid_kernel grid=(512,1,1) block=(512,1,1) lds=66560
.amdgcn_target "amdgcn-amd-amdhsa--gfx950"

.text
.globl g1_kernel
.p2align 8
.type g1_kernel,@function
g1_kernel:
    s_cmp_ge_u32 s2, 256
    s_cbranch_scc1 L_g1_kernel_end
    s_load_dwordx16 s[40:55], s[0:1], 0
    s_load_dwordx8 s[56:63], s[0:1], 64
    v_and_b32 v1, 63, v0
    v_lshrrev_b32 v2, 6, v0
    s_nop 0
    v_readfirstlane_b32 s34, v2
    s_and_b32 s35, s2, 7
    s_lshr_b32 s36, s2, 3
    v_and_b32 v3, 3, v2
    s_and_b32 s69, s34, 3
    s_and_b32 s37, s36, 15
    s_and_b32 s38, s35, 3
    s_lshl_b32 s38, s38, 2
    s_and_b32 s39, s37, 3
    s_add_u32 s70, s38, s39
    s_lshr_b32 s38, s35, 2
    s_lshl_b32 s38, s38, 2
    s_lshr_b32 s39, s37, 2
    s_add_u32 s71, s38, s39
    s_lshl_b32 s79, s39, 1
    s_and_b32 s39, s37, 1
    s_add_u32 s79, s79, s39
    s_lshr_b32 s39, s36, 4
    s_add_u32 s79, s79, s39
    s_and_b32 s39, s37, 2
    s_lshl_b32 s39, s39, 1
    s_add_u32 s79, s79, s39
    s_and_b32 s79, s79, 7
    s_lshl_b32 s32, s70, 7
    s_lshl_b32 s33, s71, 6
    s_lshr_b32 s37, s34, 1
    s_and_b32 s38, s34, 1
    s_waitcnt lgkmcnt(0)
    s_mov_b32 s4, s40
    s_mov_b32 s5, s41
    s_mov_b32 s6, 0x200000
    s_mov_b32 s7, 0x20000
    s_cmp_ge_u32 s36, 16
    s_cbranch_scc1 L_g1_w1
    s_mov_b32 s8, s42
    s_mov_b32 s9, s43
    s_mov_b32 s10, 0x180000
    s_mov_b32 s11, 0x20000
    s_mov_b32 s12, s62
    s_mov_b32 s13, s63
    s_mov_b32 s14, 0x600000
    s_mov_b32 s15, 0x20000
    s_add_u32 s16, s62, 0x1304000
    s_addc_u32 s17, s63, 0
    s_mov_b32 s18, 0x1000
    s_mov_b32 s19, 0x20000
    s_cmp_lt_u32 s34, 4
    s_cbranch_scc1 L_g1_qkv_c
    s_mul_i32 s28, s69, 4096
    s_mul_i32 s29, s69, 6144
    s_add_u32 s29, s29, 16384
    v_lshrrev_b32 v178, 3, v1
    v_mul_u32_u24 v179, 32, v3
    v_add3_u32 v178, v178, v179, s32
    v_lshrrev_b32 v179, 4, v1
    v_and_b32 v180, 7, v1
    v_xor_b32 v181, v180, v179
    v_xor_b32 v182, 4, v181
    v_lshlrev_b32 v181, 4, v181
    v_lshlrev_b32 v182, 4, v182
    s_mov_b32 s30, 1024
    v_mul_lo_u32 v183, v178, s30
    v_add_u32 v140, v183, v181
    v_add_u32 v141, v183, v182
    v_add_u32 v141, 0x2000, v141
    v_add_u32 v142, v183, v181
    v_add_u32 v142, 0x4000, v142
    v_add_u32 v143, v183, v182
    v_add_u32 v143, 0x6000, v143
    s_mov_b32 s31, 0xaaaaaab
    s_mov_b32 s30, 3072
    s_lshl_b32 s76, s33, 1
    v_mul_u32_u24 v178, 384, v3
    v_add3_u32 v178, v178, v1, 0
    v_mul_hi_u32 v179, v178, s31
    v_mul_u32_u24 v180, 24, v179
    v_sub_u32 v180, v178, v180
    v_bfe_u32 v181, v179, 1, 1
    v_lshlrev_b32 v181, 2, v181
    v_xor_b32 v180, v180, v181
    v_lshrrev_b32 v181, 3, v180
    v_and_b32 v180, 7, v180
    v_lshlrev_b32 v182, 10, v181
    v_lshl_add_u32 v182, v180, 4, v182
    v_mul_lo_u32 v144, v179, s30
    v_add3_u32 v144, v144, v182, s76
    v_mul_u32_u24 v178, 384, v3
    v_add3_u32 v178, v178, v1, 64
    v_mul_hi_u32 v179, v178, s31
    v_mul_u32_u24 v180, 24, v179
    v_sub_u32 v180, v178, v180
    v_bfe_u32 v181, v179, 1, 1
    v_lshlrev_b32 v181, 2, v181
    v_xor_b32 v180, v180, v181
    v_lshrrev_b32 v181, 3, v180
    v_and_b32 v180, 7, v180
    v_lshlrev_b32 v182, 10, v181
    v_lshl_add_u32 v182, v180, 4, v182
    v_mul_lo_u32 v145, v179, s30
    v_add3_u32 v145, v145, v182, s76
    v_mul_u32_u24 v178, 384, v3
    v_add_u32 v178, 128, v178
    v_add_u32 v178, v178, v1
    v_mul_hi_u32 v179, v178, s31
    v_mul_u32_u24 v180, 24, v179
    v_sub_u32 v180, v178, v180
    v_bfe_u32 v181, v179, 1, 1
    v_lshlrev_b32 v181, 2, v181
    v_xor_b32 v180, v180, v181
    v_lshrrev_b32 v181, 3, v180
    v_and_b32 v180, 7, v180
    v_lshlrev_b32 v182, 10, v181
    v_lshl_add_u32 v182, v180, 4, v182
    v_mul_lo_u32 v146, v179, s30
    v_add3_u32 v146, v146, v182, s76
    v_mul_u32_u24 v178, 384, v3
    v_add_u32 v178, 192, v178
    v_add_u32 v178, v178, v1
    v_mul_hi_u32 v179, v178, s31
    v_mul_u32_u24 v180, 24, v179
    v_sub_u32 v180, v178, v180
    v_bfe_u32 v181, v179, 1, 1
    v_lshlrev_b32 v181, 2, v181
    v_xor_b32 v180, v180, v181
    v_lshrrev_b32 v181, 3, v180
    v_and_b32 v180, 7, v180
    v_lshlrev_b32 v182, 10, v181
    v_lshl_add_u32 v182, v180, 4, v182
    v_mul_lo_u32 v147, v179, s30
    v_add3_u32 v147, v147, v182, s76
    v_mul_u32_u24 v178, 384, v3
    v_add_u32 v178, 256, v178
    v_add_u32 v178, v178, v1
    v_mul_hi_u32 v179, v178, s31
    v_mul_u32_u24 v180, 24, v179
    v_sub_u32 v180, v178, v180
    v_bfe_u32 v181, v179, 1, 1
    v_lshlrev_b32 v181, 2, v181
    v_xor_b32 v180, v180, v181
    v_lshrrev_b32 v181, 3, v180
    v_and_b32 v180, 7, v180
    v_lshlrev_b32 v182, 10, v181
    v_lshl_add_u32 v182, v180, 4, v182
    v_mul_lo_u32 v148, v179, s30
    v_add3_u32 v148, v148, v182, s76
    v_mul_u32_u24 v178, 384, v3
    v_add_u32 v178, 320, v178
    v_add_u32 v178, v178, v1
    v_mul_hi_u32 v179, v178, s31
    v_mul_u32_u24 v180, 24, v179
    v_sub_u32 v180, v178, v180
    v_bfe_u32 v181, v179, 1, 1
    v_lshlrev_b32 v181, 2, v181
    v_xor_b32 v180, v180, v181
    v_lshrrev_b32 v181, 3, v180
    v_and_b32 v180, 7, v180
    v_lshlrev_b32 v182, 10, v181
    v_lshl_add_u32 v182, v180, 4, v182
    v_mul_lo_u32 v149, v179, s30
    v_add3_u32 v149, v149, v182, s76
    v_subrev_u32 v141, 1024, v141
    v_subrev_u32 v142, 2048, v142
    v_subrev_u32 v143, 3072, v143
    v_subrev_u32 v145, 1024, v145
    v_subrev_u32 v146, 2048, v146
    v_subrev_u32 v147, 3072, v147
    v_subrev_u32 v149, 1024, v149
    s_mul_i32 s30, s79, 0x80
    s_add_u32 m0, s28, 0x0
    s_nop 0
    buffer_load_dwordx4 v140, s[4:7], s30 offen offset:0 lds
    buffer_load_dwordx4 v141, s[4:7], s30 offen offset:1024 lds
    buffer_load_dwordx4 v142, s[4:7], s30 offen offset:2048 lds
    buffer_load_dwordx4 v143, s[4:7], s30 offen offset:3072 lds
    s_mul_i32 s31, s79, 0x30000
    s_add_u32 m0, s29, 0x0
    s_nop 0
    buffer_load_dwordx4 v144, s[8:11], s31 offen offset:0 lds
    buffer_load_dwordx4 v145, s[8:11], s31 offen offset:1024 lds
    buffer_load_dwordx4 v146, s[8:11], s31 offen offset:2048 lds
    buffer_load_dwordx4 v147, s[8:11], s31 offen offset:3072 lds
    s_add_u32 m0, s29, 0x1000
    s_nop 0
    buffer_load_dwordx4 v148, s[8:11], s31 offen offset:0 lds
    buffer_load_dwordx4 v149, s[8:11], s31 offen offset:1024 lds
    s_add_u32 s30, s30, 0x80
    s_cmp_eq_u32 s30, 0x400
    s_cselect_b32 s30, 0x0, s30
    s_add_u32 m0, s28, 0xa000
    s_nop 0
    buffer_load_dwordx4 v140, s[4:7], s30 offen offset:0 lds
    buffer_load_dwordx4 v141, s[4:7], s30 offen offset:1024 lds
    buffer_load_dwordx4 v142, s[4:7], s30 offen offset:2048 lds
    buffer_load_dwordx4 v143, s[4:7], s30 offen offset:3072 lds
    s_add_u32 s31, s31, 0x30000
    s_cmp_eq_u32 s31, 0x180000
    s_cselect_b32 s31, 0x0, s31
    s_add_u32 m0, s29, 0xa000
    s_nop 0
    buffer_load_dwordx4 v144, s[8:11], s31 offen offset:0 lds
    buffer_load_dwordx4 v145, s[8:11], s31 offen offset:1024 lds
    buffer_load_dwordx4 v146, s[8:11], s31 offen offset:2048 lds
    buffer_load_dwordx4 v147, s[8:11], s31 offen offset:3072 lds
    s_add_u32 m0, s29, 0xb000
    s_nop 0
    buffer_load_dwordx4 v148, s[8:11], s31 offen offset:0 lds
    buffer_load_dwordx4 v149, s[8:11], s31 offen offset:1024 lds
    s_waitcnt vmcnt(10)
    s_barrier
    s_add_u32 s30, s30, 0x80
    s_cmp_eq_u32 s30, 0x400
    s_cselect_b32 s30, 0x0, s30
    s_add_u32 m0, s28, 0x14000
    s_nop 0
    buffer_load_dwordx4 v140, s[4:7], s30 offen offset:0 lds
    buffer_load_dwordx4 v141, s[4:7], s30 offen offset:1024 lds
    buffer_load_dwordx4 v142, s[4:7], s30 offen offset:2048 lds
    buffer_load_dwordx4 v143, s[4:7], s30 offen offset:3072 lds
    s_add_u32 s31, s31, 0x30000
    s_cmp_eq_u32 s31, 0x180000
    s_cselect_b32 s31, 0x0, s31
    s_add_u32 m0, s29, 0x14000
    s_nop 0
    buffer_load_dwordx4 v144, s[8:11], s31 offen offset:0 lds
    buffer_load_dwordx4 v145, s[8:11], s31 offen offset:1024 lds
    buffer_load_dwordx4 v146, s[8:11], s31 offen offset:2048 lds
    buffer_load_dwordx4 v147, s[8:11], s31 offen offset:3072 lds
    s_add_u32 m0, s29, 0x15000
    s_nop 0
    buffer_load_dwordx4 v148, s[8:11], s31 offen offset:0 lds
    buffer_load_dwordx4 v149, s[8:11], s31 offen offset:1024 lds
    s_add_u32 s30, s30, 0x80
    s_cmp_eq_u32 s30, 0x400
    s_cselect_b32 s30, 0x0, s30
    s_add_u32 m0, s28, 0x1e000
    s_nop 0
    buffer_load_dwordx4 v140, s[4:7], s30 offen offset:0 lds
    buffer_load_dwordx4 v141, s[4:7], s30 offen offset:1024 lds
    buffer_load_dwordx4 v142, s[4:7], s30 offen offset:2048 lds
    buffer_load_dwordx4 v143, s[4:7], s30 offen offset:3072 lds
    s_add_u32 s31, s31, 0x30000
    s_cmp_eq_u32 s31, 0x180000
    s_cselect_b32 s31, 0x0, s31
    s_add_u32 m0, s29, 0x1e000
    s_nop 0
    buffer_load_dwordx4 v144, s[8:11], s31 offen offset:0 lds
    buffer_load_dwordx4 v145, s[8:11], s31 offen offset:1024 lds
    buffer_load_dwordx4 v146, s[8:11], s31 offen offset:2048 lds
    buffer_load_dwordx4 v147, s[8:11], s31 offen offset:3072 lds
    s_add_u32 m0, s29, 0x1f000
    s_nop 0
    buffer_load_dwordx4 v148, s[8:11], s31 offen offset:0 lds
    buffer_load_dwordx4 v149, s[8:11], s31 offen offset:1024 lds
    s_waitcnt vmcnt(20)
    s_barrier
    s_add_u32 s30, s30, 0x80
    s_cmp_eq_u32 s30, 0x400
    s_cselect_b32 s30, 0x0, s30
    s_add_u32 m0, s28, 0x0
    s_nop 0
    buffer_load_dwordx4 v140, s[4:7], s30 offen offset:0 lds
    buffer_load_dwordx4 v141, s[4:7], s30 offen offset:1024 lds
    buffer_load_dwordx4 v142, s[4:7], s30 offen offset:2048 lds
    buffer_load_dwordx4 v143, s[4:7], s30 offen offset:3072 lds
    s_add_u32 s31, s31, 0x30000
    s_cmp_eq_u32 s31, 0x180000
    s_cselect_b32 s31, 0x0, s31
    s_add_u32 m0, s29, 0x0
    s_nop 0
    buffer_load_dwordx4 v144, s[8:11], s31 offen offset:0 lds
    buffer_load_dwordx4 v145, s[8:11], s31 offen offset:1024 lds
    buffer_load_dwordx4 v146, s[8:11], s31 offen offset:2048 lds
    buffer_load_dwordx4 v147, s[8:11], s31 offen offset:3072 lds
    s_add_u32 m0, s29, 0x1000
    s_nop 0
    buffer_load_dwordx4 v148, s[8:11], s31 offen offset:0 lds
    buffer_load_dwordx4 v149, s[8:11], s31 offen offset:1024 lds
    s_waitcnt vmcnt(20)
    s_barrier
    s_add_u32 s30, s30, 0x80
    s_cmp_eq_u32 s30, 0x400
    s_cselect_b32 s30, 0x0, s30
    s_add_u32 m0, s28, 0xa000
    s_nop 0
    buffer_load_dwordx4 v140, s[4:7], s30 offen offset:0 lds
    buffer_load_dwordx4 v141, s[4:7], s30 offen offset:1024 lds
    buffer_load_dwordx4 v142, s[4:7], s30 offen offset:2048 lds
    buffer_load_dwordx4 v143, s[4:7], s30 offen offset:3072 lds
    s_add_u32 s31, s31, 0x30000
    s_cmp_eq_u32 s31, 0x180000
    s_cselect_b32 s31, 0x0, s31
    s_add_u32 m0, s29, 0xa000
    s_nop 0
    buffer_load_dwordx4 v144, s[8:11], s31 offen offset:0 lds
    buffer_load_dwordx4 v145, s[8:11], s31 offen offset:1024 lds
    buffer_load_dwordx4 v146, s[8:11], s31 offen offset:2048 lds
    buffer_load_dwordx4 v147, s[8:11], s31 offen offset:3072 lds
    s_add_u32 m0, s29, 0xb000
    s_nop 0
    buffer_load_dwordx4 v148, s[8:11], s31 offen offset:0 lds
    buffer_load_dwordx4 v149, s[8:11], s31 offen offset:1024 lds
    s_waitcnt vmcnt(20)
    s_barrier
    s_add_u32 s30, s30, 0x80
    s_cmp_eq_u32 s30, 0x400
    s_cselect_b32 s30, 0x0, s30
    s_add_u32 m0, s28, 0x14000
    s_nop 0
    buffer_load_dwordx4 v140, s[4:7], s30 offen offset:0 lds
    buffer_load_dwordx4 v141, s[4:7], s30 offen offset:1024 lds
    buffer_load_dwordx4 v142, s[4:7], s30 offen offset:2048 lds
    buffer_load_dwordx4 v143, s[4:7], s30 offen offset:3072 lds
    s_add_u32 s31, s31, 0x30000
    s_cmp_eq_u32 s31, 0x180000
    s_cselect_b32 s31, 0x0, s31
    s_add_u32 m0, s29, 0x14000
    s_nop 0
    buffer_load_dwordx4 v144, s[8:11], s31 offen offset:0 lds
    buffer_load_dwordx4 v145, s[8:11], s31 offen offset:1024 lds
    buffer_load_dwordx4 v146, s[8:11], s31 offen offset:2048 lds
    buffer_load_dwordx4 v147, s[8:11], s31 offen offset:3072 lds
    s_add_u32 m0, s29, 0x15000
    s_nop 0
    buffer_load_dwordx4 v148, s[8:11], s31 offen offset:0 lds
    buffer_load_dwordx4 v149, s[8:11], s31 offen offset:1024 lds
    s_waitcnt vmcnt(20)
    s_barrier
    s_add_u32 s30, s30, 0x80
    s_cmp_eq_u32 s30, 0x400
    s_cselect_b32 s30, 0x0, s30
    s_add_u32 m0, s28, 0x1e000
    s_nop 0
    buffer_load_dwordx4 v140, s[4:7], s30 offen offset:0 lds
    buffer_load_dwordx4 v141, s[4:7], s30 offen offset:1024 lds
    buffer_load_dwordx4 v142, s[4:7], s30 offen offset:2048 lds
    buffer_load_dwordx4 v143, s[4:7], s30 offen offset:3072 lds
    s_add_u32 s31, s31, 0x30000
    s_cmp_eq_u32 s31, 0x180000
    s_cselect_b32 s31, 0x0, s31
    s_add_u32 m0, s29, 0x1e000
    s_nop 0
    buffer_load_dwordx4 v144, s[8:11], s31 offen offset:0 lds
    buffer_load_dwordx4 v145, s[8:11], s31 offen offset:1024 lds
    buffer_load_dwordx4 v146, s[8:11], s31 offen offset:2048 lds
    buffer_load_dwordx4 v147, s[8:11], s31 offen offset:3072 lds
    s_add_u32 m0, s29, 0x1f000
    s_nop 0
    buffer_load_dwordx4 v148, s[8:11], s31 offen offset:0 lds
    buffer_load_dwordx4 v149, s[8:11], s31 offen offset:1024 lds
    s_waitcnt vmcnt(20)
    s_barrier
    s_waitcnt vmcnt(10)
    s_barrier
    s_waitcnt vmcnt(0)
    s_barrier
    s_branch L_g1_kernel_fin
L_g1_qkv_c:
    v_lshrrev_b32 v178, 1, v2
    v_and_b32 v179, 1, v2
    v_and_b32 v180, 31, v1
    v_lshrrev_b32 v181, 5, v1
    v_mul_u32_u24 v182, 8192, v178
    v_lshl_add_u32 v182, v180, 7, v182
    v_bfe_u32 v183, v1, 1, 3
    v_xor_b32 v183, v183, v181
    v_xor_b32 v150, 0, v183
    v_lshl_add_u32 v150, v150, 4, v182
    v_add_u32 v154, 0xa000, v150
    v_add_u32 v158, 0x14000, v150
    v_add_u32 v162, 0x1e000, v150
    v_xor_b32 v151, 2, v183
    v_lshl_add_u32 v151, v151, 4, v182
    v_add_u32 v155, 0xa000, v151
    v_add_u32 v159, 0x14000, v151
    v_add_u32 v163, 0x1e000, v151
    v_xor_b32 v152, 4, v183
    v_lshl_add_u32 v152, v152, 4, v182
    v_add_u32 v156, 0xa000, v152
    v_add_u32 v160, 0x14000, v152
    v_add_u32 v164, 0x1e000, v152
    v_xor_b32 v153, 6, v183
    v_lshl_add_u32 v153, v153, 4, v182
    v_add_u32 v157, 0xa000, v153
    v_add_u32 v161, 0x14000, v153
    v_add_u32 v165, 0x1e000, v153
    v_bfe_u32 v180, v1, 2, 2
    v_lshl_add_u32 v182, v181, 3, v180
    v_mul_u32_u24 v182, 384, v182
    v_and_b32 v183, 1, v1
    v_lshl_add_u32 v182, v183, 3, v182
    v_lshrrev_b32 v180, 1, v180
    v_lshlrev_b32 v180, 2, v180
    v_bfe_u32 v183, v1, 4, 1
    v_lshlrev_b32 v183, 1, v183
    v_bfe_u32 v181, v1, 1, 1
    v_add_u32 v183, v183, v181
    v_mul_u32_u24 v181, 4, v179
    v_add_u32 v183, v183, v181
    v_add_u32 v166, 0, v183
    v_xor_b32 v166, v166, v180
    v_lshl_add_u32 v166, v166, 4, v182
    v_add_u32 v169, 0xa000, v166
    v_add_u32 v172, 0x14000, v166
    v_add_u32 v175, 0x1e000, v166
    v_add_u32 v167, 8, v183
    v_xor_b32 v167, v167, v180
    v_lshl_add_u32 v167, v167, 4, v182
    v_add_u32 v170, 0xa000, v167
    v_add_u32 v173, 0x14000, v167
    v_add_u32 v176, 0x1e000, v167
    v_add_u32 v168, 16, v183
    v_xor_b32 v168, v168, v180
    v_lshl_add_u32 v168, v168, 4, v182
    v_add_u32 v171, 0xa000, v168
    v_add_u32 v174, 0x14000, v168
    v_add_u32 v177, 0x1e000, v168
    s_lshl_b32 s74, s71, 18
    s_lshl_b32 s39, s38, 17
    s_add_u32 s74, s74, s39
    s_lshl_b32 s39, s70, 12
    s_add_u32 s74, s74, s39
    s_lshl_b32 s39, s37, 11
    s_add_u32 s74, s74, s39
    v_lshlrev_b32 v184, 4, v1
    v_bfe_u32 v185, v1, 4, 1
    v_lshlrev_b32 v185, 16, v185
    v_lshrrev_b32 v186, 5, v1
    v_lshl_add_u32 v185, v186, 8, v185
    v_and_b32 v186, 15, v1
    v_lshl_add_u32 v185, v186, 4, v185
    s_barrier
    ds_read_b128 v[100:103], v150 offset:0
    ds_read_b64_tr_b16 v[116:117], v166 offset:16384
    ds_read_b64_tr_b16 v[118:119], v166 offset:17920
    ds_read_b64_tr_b16 v[120:121], v167 offset:16384
    ds_read_b64_tr_b16 v[122:123], v167 offset:17920
    ds_read_b64_tr_b16 v[124:125], v168 offset:16384
    ds_read_b64_tr_b16 v[126:127], v168 offset:17920
    ds_read_b128 v[104:107], v150 offset:4096
    s_waitcnt lgkmcnt(0)
    v_mfma_f32_32x32x16_bf16 v[4:19], v[116:119], v[100:103], 0
    ds_read_b128 v[108:111], v151 offset:0
    ds_read_b64_tr_b16 v[128:129], v166 offset:22528
    v_mfma_f32_32x32x16_bf16 v[20:35], v[120:123], v[100:103], 0
    ds_read_b64_tr_b16 v[130:131], v166 offset:24064
    ds_read_b64_tr_b16 v[132:133], v167 offset:22528
    v_mfma_f32_32x32x16_bf16 v[36:51], v[100:103], v[124:127], 0
    ds_read_b64_tr_b16 v[134:135], v167 offset:24064
    ds_read_b64_tr_b16 v[136:137], v168 offset:22528
    v_mfma_f32_32x32x16_bf16 v[52:67], v[116:119], v[104:107], 0
    ds_read_b64_tr_b16 v[138:139], v168 offset:24064
    ds_read_b128 v[112:115], v151 offset:4096
    v_mfma_f32_32x32x16_bf16 v[68:83], v[120:123], v[104:107], 0
    v_mfma_f32_32x32x16_bf16 v[84:99], v[104:107], v[124:127], 0
    s_waitcnt lgkmcnt(0)
    v_mfma_f32_32x32x16_bf16 v[4:19], v[128:131], v[108:111], v[4:19]
    ds_read_b128 v[100:103], v152 offset:0
    ds_read_b64_tr_b16 v[116:117], v166 offset:28672
    v_mfma_f32_32x32x16_bf16 v[20:35], v[132:135], v[108:111], v[20:35]
    ds_read_b64_tr_b16 v[118:119], v166 offset:30208
    ds_read_b64_tr_b16 v[120:121], v167 offset:28672
    v_mfma_f32_32x32x16_bf16 v[36:51], v[108:111], v[136:139], v[36:51]
    ds_read_b64_tr_b16 v[122:123], v167 offset:30208
    ds_read_b64_tr_b16 v[124:125], v168 offset:28672
    v_mfma_f32_32x32x16_bf16 v[52:67], v[128:131], v[112:115], v[52:67]
    ds_read_b64_tr_b16 v[126:127], v168 offset:30208
    ds_read_b128 v[104:107], v152 offset:4096
    v_mfma_f32_32x32x16_bf16 v[68:83], v[132:135], v[112:115], v[68:83]
    v_mfma_f32_32x32x16_bf16 v[84:99], v[112:115], v[136:139], v[84:99]
    s_waitcnt lgkmcnt(0)
    v_mfma_f32_32x32x16_bf16 v[4:19], v[116:119], v[100:103], v[4:19]
    ds_read_b128 v[108:111], v153 offset:0
    ds_read_b64_tr_b16 v[128:129], v166 offset:34816
    v_mfma_f32_32x32x16_bf16 v[20:35], v[120:123], v[100:103], v[20:35]
    ds_read_b64_tr_b16 v[130:131], v166 offset:36352
    ds_read_b64_tr_b16 v[132:133], v167 offset:34816
    v_mfma_f32_32x32x16_bf16 v[36:51], v[100:103], v[124:127], v[36:51]
    ds_read_b64_tr_b16 v[134:135], v167 offset:36352
    ds_read_b64_tr_b16 v[136:137], v168 offset:34816
    v_mfma_f32_32x32x16_bf16 v[52:67], v[116:119], v[104:107], v[52:67]
    ds_read_b64_tr_b16 v[138:139], v168 offset:36352
    ds_read_b128 v[112:115], v153 offset:4096
    v_mfma_f32_32x32x16_bf16 v[68:83], v[120:123], v[104:107], v[68:83]
    v_mfma_f32_32x32x16_bf16 v[84:99], v[104:107], v[124:127], v[84:99]
    s_waitcnt lgkmcnt(0)
    s_barrier
    v_mfma_f32_32x32x16_bf16 v[4:19], v[128:131], v[108:111], v[4:19]
    ds_read_b128 v[100:103], v154 offset:0
    ds_read_b64_tr_b16 v[116:117], v169 offset:16384
    v_mfma_f32_32x32x16_bf16 v[20:35], v[132:135], v[108:111], v[20:35]
    ds_read_b64_tr_b16 v[118:119], v169 offset:17920
    ds_read_b64_tr_b16 v[120:121], v170 offset:16384
    v_mfma_f32_32x32x16_bf16 v[36:51], v[108:111], v[136:139], v[36:51]
    ds_read_b64_tr_b16 v[122:123], v170 offset:17920
    ds_read_b64_tr_b16 v[124:125], v171 offset:16384
    v_mfma_f32_32x32x16_bf16 v[52:67], v[128:131], v[112:115], v[52:67]
    ds_read_b64_tr_b16 v[126:127], v171 offset:17920
    ds_read_b128 v[104:107], v154 offset:4096
    v_mfma_f32_32x32x16_bf16 v[68:83], v[132:135], v[112:115], v[68:83]
    v_mfma_f32_32x32x16_bf16 v[84:99], v[112:115], v[136:139], v[84:99]
    s_waitcnt lgkmcnt(0)
    v_mfma_f32_32x32x16_bf16 v[4:19], v[116:119], v[100:103], v[4:19]
    ds_read_b128 v[108:111], v155 offset:0
    ds_read_b64_tr_b16 v[128:129], v169 offset:22528
    v_mfma_f32_32x32x16_bf16 v[20:35], v[120:123], v[100:103], v[20:35]
    ds_read_b64_tr_b16 v[130:131], v169 offset:24064
    ds_read_b64_tr_b16 v[132:133], v170 offset:22528
    v_mfma_f32_32x32x16_bf16 v[36:51], v[100:103], v[124:127], v[36:51]
    ds_read_b64_tr_b16 v[134:135], v170 offset:24064
    ds_read_b64_tr_b16 v[136:137], v171 offset:22528
    v_mfma_f32_32x32x16_bf16 v[52:67], v[116:119], v[104:107], v[52:67]
    ds_read_b64_tr_b16 v[138:139], v171 offset:24064
    ds_read_b128 v[112:115], v155 offset:4096
    v_mfma_f32_32x32x16_bf16 v[68:83], v[120:123], v[104:107], v[68:83]
    v_mfma_f32_32x32x16_bf16 v[84:99], v[104:107], v[124:127], v[84:99]
    s_waitcnt lgkmcnt(0)
    v_mfma_f32_32x32x16_bf16 v[4:19], v[128:131], v[108:111], v[4:19]
    ds_read_b128 v[100:103], v156 offset:0
    ds_read_b64_tr_b16 v[116:117], v169 offset:28672
    v_mfma_f32_32x32x16_bf16 v[20:35], v[132:135], v[108:111], v[20:35]
    ds_read_b64_tr_b16 v[118:119], v169 offset:30208
    ds_read_b64_tr_b16 v[120:121], v170 offset:28672
    v_mfma_f32_32x32x16_bf16 v[36:51], v[108:111], v[136:139], v[36:51]
    ds_read_b64_tr_b16 v[122:123], v170 offset:30208
    ds_read_b64_tr_b16 v[124:125], v171 offset:28672
    v_mfma_f32_32x32x16_bf16 v[52:67], v[128:131], v[112:115], v[52:67]
    ds_read_b64_tr_b16 v[126:127], v171 offset:30208
    ds_read_b128 v[104:107], v156 offset:4096
    v_mfma_f32_32x32x16_bf16 v[68:83], v[132:135], v[112:115], v[68:83]
    v_mfma_f32_32x32x16_bf16 v[84:99], v[112:115], v[136:139], v[84:99]
    s_waitcnt lgkmcnt(0)
    v_mfma_f32_32x32x16_bf16 v[4:19], v[116:119], v[100:103], v[4:19]
    ds_read_b128 v[108:111], v157 offset:0
    ds_read_b64_tr_b16 v[128:129], v169 offset:34816
    v_mfma_f32_32x32x16_bf16 v[20:35], v[120:123], v[100:103], v[20:35]
    ds_read_b64_tr_b16 v[130:131], v169 offset:36352
    ds_read_b64_tr_b16 v[132:133], v170 offset:34816
    v_mfma_f32_32x32x16_bf16 v[36:51], v[100:103], v[124:127], v[36:51]
    ds_read_b64_tr_b16 v[134:135], v170 offset:36352
    ds_read_b64_tr_b16 v[136:137], v171 offset:34816
    v_mfma_f32_32x32x16_bf16 v[52:67], v[116:119], v[104:107], v[52:67]
    ds_read_b64_tr_b16 v[138:139], v171 offset:36352
    ds_read_b128 v[112:115], v157 offset:4096
    v_mfma_f32_32x32x16_bf16 v[68:83], v[120:123], v[104:107], v[68:83]
    v_mfma_f32_32x32x16_bf16 v[84:99], v[104:107], v[124:127], v[84:99]
    s_waitcnt lgkmcnt(0)
    s_barrier
    v_mfma_f32_32x32x16_bf16 v[4:19], v[128:131], v[108:111], v[4:19]
    ds_read_b128 v[100:103], v158 offset:0
    ds_read_b64_tr_b16 v[116:117], v172 offset:16384
    v_mfma_f32_32x32x16_bf16 v[20:35], v[132:135], v[108:111], v[20:35]
    ds_read_b64_tr_b16 v[118:119], v172 offset:17920
    ds_read_b64_tr_b16 v[120:121], v173 offset:16384
    v_mfma_f32_32x32x16_bf16 v[36:51], v[108:111], v[136:139], v[36:51]
    ds_read_b64_tr_b16 v[122:123], v173 offset:17920
    ds_read_b64_tr_b16 v[124:125], v174 offset:16384
    v_mfma_f32_32x32x16_bf16 v[52:67], v[128:131], v[112:115], v[52:67]
    ds_read_b64_tr_b16 v[126:127], v174 offset:17920
    ds_read_b128 v[104:107], v158 offset:4096
    v_mfma_f32_32x32x16_bf16 v[68:83], v[132:135], v[112:115], v[68:83]
    v_mfma_f32_32x32x16_bf16 v[84:99], v[112:115], v[136:139], v[84:99]
    s_waitcnt lgkmcnt(0)
    v_mfma_f32_32x32x16_bf16 v[4:19], v[116:119], v[100:103], v[4:19]
    ds_read_b128 v[108:111], v159 offset:0
    ds_read_b64_tr_b16 v[128:129], v172 offset:22528
    v_mfma_f32_32x32x16_bf16 v[20:35], v[120:123], v[100:103], v[20:35]
    ds_read_b64_tr_b16 v[130:131], v172 offset:24064
    ds_read_b64_tr_b16 v[132:133], v173 offset:22528
    v_mfma_f32_32x32x16_bf16 v[36:51], v[100:103], v[124:127], v[36:51]
    ds_read_b64_tr_b16 v[134:135], v173 offset:24064
    ds_read_b64_tr_b16 v[136:137], v174 offset:22528
    v_mfma_f32_32x32x16_bf16 v[52:67], v[116:119], v[104:107], v[52:67]
    ds_read_b64_tr_b16 v[138:139], v174 offset:24064
    ds_read_b128 v[112:115], v159 offset:4096
    v_mfma_f32_32x32x16_bf16 v[68:83], v[120:123], v[104:107], v[68:83]
    v_mfma_f32_32x32x16_bf16 v[84:99], v[104:107], v[124:127], v[84:99]
    s_waitcnt lgkmcnt(0)
    v_mfma_f32_32x32x16_bf16 v[4:19], v[128:131], v[108:111], v[4:19]
    ds_read_b128 v[100:103], v160 offset:0
    ds_read_b64_tr_b16 v[116:117], v172 offset:28672
    v_mfma_f32_32x32x16_bf16 v[20:35], v[132:135], v[108:111], v[20:35]
    ds_read_b64_tr_b16 v[118:119], v172 offset:30208
    ds_read_b64_tr_b16 v[120:121], v173 offset:28672
    v_mfma_f32_32x32x16_bf16 v[36:51], v[108:111], v[136:139], v[36:51]
    ds_read_b64_tr_b16 v[122:123], v173 offset:30208
    ds_read_b64_tr_b16 v[124:125], v174 offset:28672
    v_mfma_f32_32x32x16_bf16 v[52:67], v[128:131], v[112:115], v[52:67]
    ds_read_b64_tr_b16 v[126:127], v174 offset:30208
    ds_read_b128 v[104:107], v160 offset:4096
    v_mfma_f32_32x32x16_bf16 v[68:83], v[132:135], v[112:115], v[68:83]
    v_mfma_f32_32x32x16_bf16 v[84:99], v[112:115], v[136:139], v[84:99]
    s_waitcnt lgkmcnt(0)
    v_mfma_f32_32x32x16_bf16 v[4:19], v[116:119], v[100:103], v[4:19]
    ds_read_b128 v[108:111], v161 offset:0
    ds_read_b64_tr_b16 v[128:129], v172 offset:34816
    v_mfma_f32_32x32x16_bf16 v[20:35], v[120:123], v[100:103], v[20:35]
    ds_read_b64_tr_b16 v[130:131], v172 offset:36352
    ds_read_b64_tr_b16 v[132:133], v173 offset:34816
    v_mfma_f32_32x32x16_bf16 v[36:51], v[100:103], v[124:127], v[36:51]
    ds_read_b64_tr_b16 v[134:135], v173 offset:36352
    ds_read_b64_tr_b16 v[136:137], v174 offset:34816
    v_mfma_f32_32x32x16_bf16 v[52:67], v[116:119], v[104:107], v[52:67]
    ds_read_b64_tr_b16 v[138:139], v174 offset:36352
    ds_read_b128 v[112:115], v161 offset:4096
    v_mfma_f32_32x32x16_bf16 v[68:83], v[120:123], v[104:107], v[68:83]
    v_mfma_f32_32x32x16_bf16 v[84:99], v[104:107], v[124:127], v[84:99]
    s_waitcnt lgkmcnt(0)
    s_barrier
    v_mfma_f32_32x32x16_bf16 v[4:19], v[128:131], v[108:111], v[4:19]
    ds_read_b128 v[100:103], v162 offset:0
    ds_read_b64_tr_b16 v[116:117], v175 offset:16384
    v_mfma_f32_32x32x16_bf16 v[20:35], v[132:135], v[108:111], v[20:35]
    ds_read_b64_tr_b16 v[118:119], v175 offset:17920
    ds_read_b64_tr_b16 v[120:121], v176 offset:16384
    v_mfma_f32_32x32x16_bf16 v[36:51], v[108:111], v[136:139], v[36:51]
    ds_read_b64_tr_b16 v[122:123], v176 offset:17920
    ds_read_b64_tr_b16 v[124:125], v177 offset:16384
    v_mfma_f32_32x32x16_bf16 v[52:67], v[128:131], v[112:115], v[52:67]
    ds_read_b64_tr_b16 v[126:127], v177 offset:17920
    ds_read_b128 v[104:107], v162 offset:4096
    v_mfma_f32_32x32x16_bf16 v[68:83], v[132:135], v[112:115], v[68:83]
    v_mfma_f32_32x32x16_bf16 v[84:99], v[112:115], v[136:139], v[84:99]
    s_waitcnt lgkmcnt(0)
    v_mfma_f32_32x32x16_bf16 v[4:19], v[116:119], v[100:103], v[4:19]
    ds_read_b128 v[108:111], v163 offset:0
    ds_read_b64_tr_b16 v[128:129], v175 offset:22528
    v_mfma_f32_32x32x16_bf16 v[20:35], v[120:123], v[100:103], v[20:35]
    ds_read_b64_tr_b16 v[130:131], v175 offset:24064
    ds_read_b64_tr_b16 v[132:133], v176 offset:22528
    v_mfma_f32_32x32x16_bf16 v[36:51], v[100:103], v[124:127], v[36:51]
    ds_read_b64_tr_b16 v[134:135], v176 offset:24064
    ds_read_b64_tr_b16 v[136:137], v177 offset:22528
    v_mfma_f32_32x32x16_bf16 v[52:67], v[116:119], v[104:107], v[52:67]
    ds_read_b64_tr_b16 v[138:139], v177 offset:24064
    ds_read_b128 v[112:115], v163 offset:4096
    v_mfma_f32_32x32x16_bf16 v[68:83], v[120:123], v[104:107], v[68:83]
    v_mfma_f32_32x32x16_bf16 v[84:99], v[104:107], v[124:127], v[84:99]
    s_waitcnt lgkmcnt(0)
    v_mfma_f32_32x32x16_bf16 v[4:19], v[128:131], v[108:111], v[4:19]
    ds_read_b128 v[100:103], v164 offset:0
    ds_read_b64_tr_b16 v[116:117], v175 offset:28672
    v_mfma_f32_32x32x16_bf16 v[20:35], v[132:135], v[108:111], v[20:35]
    ds_read_b64_tr_b16 v[118:119], v175 offset:30208
    ds_read_b64_tr_b16 v[120:121], v176 offset:28672
    v_mfma_f32_32x32x16_bf16 v[36:51], v[108:111], v[136:139], v[36:51]
    ds_read_b64_tr_b16 v[122:123], v176 offset:30208
    ds_read_b64_tr_b16 v[124:125], v177 offset:28672
    v_mfma_f32_32x32x16_bf16 v[52:67], v[128:131], v[112:115], v[52:67]
    ds_read_b64_tr_b16 v[126:127], v177 offset:30208
    ds_read_b128 v[104:107], v164 offset:4096
    v_mfma_f32_32x32x16_bf16 v[68:83], v[132:135], v[112:115], v[68:83]
    v_mfma_f32_32x32x16_bf16 v[84:99], v[112:115], v[136:139], v[84:99]
    s_waitcnt lgkmcnt(0)
    v_mfma_f32_32x32x16_bf16 v[4:19], v[116:119], v[100:103], v[4:19]
    ds_read_b128 v[108:111], v165 offset:0
    ds_read_b64_tr_b16 v[128:129], v175 offset:34816
    v_mfma_f32_32x32x16_bf16 v[20:35], v[120:123], v[100:103], v[20:35]
    ds_read_b64_tr_b16 v[130:131], v175 offset:36352
    ds_read_b64_tr_b16 v[132:133], v176 offset:34816
    v_mfma_f32_32x32x16_bf16 v[36:51], v[100:103], v[124:127], v[36:51]
    ds_read_b64_tr_b16 v[134:135], v176 offset:36352
    ds_read_b64_tr_b16 v[136:137], v177 offset:34816
    v_mfma_f32_32x32x16_bf16 v[52:67], v[116:119], v[104:107], v[52:67]
    ds_read_b64_tr_b16 v[138:139], v177 offset:36352
    ds_read_b128 v[112:115], v165 offset:4096
    v_mfma_f32_32x32x16_bf16 v[68:83], v[120:123], v[104:107], v[68:83]
    v_mfma_f32_32x32x16_bf16 v[84:99], v[104:107], v[124:127], v[84:99]
    s_waitcnt lgkmcnt(0)
    s_barrier
    v_mfma_f32_32x32x16_bf16 v[4:19], v[128:131], v[108:111], v[4:19]
    ds_read_b128 v[100:103], v150 offset:0
    ds_read_b64_tr_b16 v[116:117], v166 offset:16384
    v_mfma_f32_32x32x16_bf16 v[20:35], v[132:135], v[108:111], v[20:35]
    ds_read_b64_tr_b16 v[118:119], v166 offset:17920
    ds_read_b64_tr_b16 v[120:121], v167 offset:16384
    v_mfma_f32_32x32x16_bf16 v[36:51], v[108:111], v[136:139], v[36:51]
    ds_read_b64_tr_b16 v[122:123], v167 offset:17920
    ds_read_b64_tr_b16 v[124:125], v168 offset:16384
    v_mfma_f32_32x32x16_bf16 v[52:67], v[128:131], v[112:115], v[52:67]
    ds_read_b64_tr_b16 v[126:127], v168 offset:17920
    ds_read_b128 v[104:107], v150 offset:4096
    v_mfma_f32_32x32x16_bf16 v[68:83], v[132:135], v[112:115], v[68:83]
    v_mfma_f32_32x32x16_bf16 v[84:99], v[112:115], v[136:139], v[84:99]
    s_waitcnt lgkmcnt(0)
    v_mfma_f32_32x32x16_bf16 v[4:19], v[116:119], v[100:103], v[4:19]
    ds_read_b128 v[108:111], v151 offset:0
    ds_read_b64_tr_b16 v[128:129], v166 offset:22528
    v_mfma_f32_32x32x16_bf16 v[20:35], v[120:123], v[100:103], v[20:35]
    ds_read_b64_tr_b16 v[130:131], v166 offset:24064
    ds_read_b64_tr_b16 v[132:133], v167 offset:22528
    v_mfma_f32_32x32x16_bf16 v[36:51], v[100:103], v[124:127], v[36:51]
    ds_read_b64_tr_b16 v[134:135], v167 offset:24064
    ds_read_b64_tr_b16 v[136:137], v168 offset:22528
    v_mfma_f32_32x32x16_bf16 v[52:67], v[116:119], v[104:107], v[52:67]
    ds_read_b64_tr_b16 v[138:139], v168 offset:24064
    ds_read_b128 v[112:115], v151 offset:4096
    v_mfma_f32_32x32x16_bf16 v[68:83], v[120:123], v[104:107], v[68:83]
    v_mfma_f32_32x32x16_bf16 v[84:99], v[104:107], v[124:127], v[84:99]
    s_waitcnt lgkmcnt(0)
    v_mfma_f32_32x32x16_bf16 v[4:19], v[128:131], v[108:111], v[4:19]
    ds_read_b128 v[100:103], v152 offset:0
    ds_read_b64_tr_b16 v[116:117], v166 offset:28672
    v_mfma_f32_32x32x16_bf16 v[20:35], v[132:135], v[108:111], v[20:35]
    ds_read_b64_tr_b16 v[118:119], v166 offset:30208
    ds_read_b64_tr_b16 v[120:121], v167 offset:28672
    v_mfma_f32_32x32x16_bf16 v[36:51], v[108:111], v[136:139], v[36:51]
    ds_read_b64_tr_b16 v[122:123], v167 offset:30208
    ds_read_b64_tr_b16 v[124:125], v168 offset:28672
    v_mfma_f32_32x32x16_bf16 v[52:67], v[128:131], v[112:115], v[52:67]
    ds_read_b64_tr_b16 v[126:127], v168 offset:30208
    ds_read_b128 v[104:107], v152 offset:4096
    v_mfma_f32_32x32x16_bf16 v[68:83], v[132:135], v[112:115], v[68:83]
    v_mfma_f32_32x32x16_bf16 v[84:99], v[112:115], v[136:139], v[84:99]
    s_waitcnt lgkmcnt(0)
    v_mfma_f32_32x32x16_bf16 v[4:19], v[116:119], v[100:103], v[4:19]
    ds_read_b128 v[108:111], v153 offset:0
    ds_read_b64_tr_b16 v[128:129], v166 offset:34816
    v_mfma_f32_32x32x16_bf16 v[20:35], v[120:123], v[100:103], v[20:35]
    ds_read_b64_tr_b16 v[130:131], v166 offset:36352
    ds_read_b64_tr_b16 v[132:133], v167 offset:34816
    v_mfma_f32_32x32x16_bf16 v[36:51], v[100:103], v[124:127], v[36:51]
    ds_read_b64_tr_b16 v[134:135], v167 offset:36352
    ds_read_b64_tr_b16 v[136:137], v168 offset:34816
    v_mfma_f32_32x32x16_bf16 v[52:67], v[116:119], v[104:107], v[52:67]
    ds_read_b64_tr_b16 v[138:139], v168 offset:36352
    ds_read_b128 v[112:115], v153 offset:4096
    v_mfma_f32_32x32x16_bf16 v[68:83], v[120:123], v[104:107], v[68:83]
    v_mfma_f32_32x32x16_bf16 v[84:99], v[104:107], v[124:127], v[84:99]
    s_waitcnt lgkmcnt(0)
    s_barrier
    v_mfma_f32_32x32x16_bf16 v[4:19], v[128:131], v[108:111], v[4:19]
    ds_read_b128 v[100:103], v154 offset:0
    ds_read_b64_tr_b16 v[116:117], v169 offset:16384
    v_mfma_f32_32x32x16_bf16 v[20:35], v[132:135], v[108:111], v[20:35]
    ds_read_b64_tr_b16 v[118:119], v169 offset:17920
    ds_read_b64_tr_b16 v[120:121], v170 offset:16384
    v_mfma_f32_32x32x16_bf16 v[36:51], v[108:111], v[136:139], v[36:51]
    ds_read_b64_tr_b16 v[122:123], v170 offset:17920
    ds_read_b64_tr_b16 v[124:125], v171 offset:16384
    v_mfma_f32_32x32x16_bf16 v[52:67], v[128:131], v[112:115], v[52:67]
    ds_read_b64_tr_b16 v[126:127], v171 offset:17920
    ds_read_b128 v[104:107], v154 offset:4096
    v_mfma_f32_32x32x16_bf16 v[68:83], v[132:135], v[112:115], v[68:83]
    v_mfma_f32_32x32x16_bf16 v[84:99], v[112:115], v[136:139], v[84:99]
    s_waitcnt lgkmcnt(0)
    v_mfma_f32_32x32x16_bf16 v[4:19], v[116:119], v[100:103], v[4:19]
    ds_read_b128 v[108:111], v155 offset:0
    ds_read_b64_tr_b16 v[128:129], v169 offset:22528
    v_mfma_f32_32x32x16_bf16 v[20:35], v[120:123], v[100:103], v[20:35]
    ds_read_b64_tr_b16 v[130:131], v169 offset:24064
    ds_read_b64_tr_b16 v[132:133], v170 offset:22528
    v_mfma_f32_32x32x16_bf16 v[36:51], v[100:103], v[124:127], v[36:51]
    ds_read_b64_tr_b16 v[134:135], v170 offset:24064
    ds_read_b64_tr_b16 v[136:137], v171 offset:22528
    v_mfma_f32_32x32x16_bf16 v[52:67], v[116:119], v[104:107], v[52:67]
    ds_read_b64_tr_b16 v[138:139], v171 offset:24064
    ds_read_b128 v[112:115], v155 offset:4096
    v_mfma_f32_32x32x16_bf16 v[68:83], v[120:123], v[104:107], v[68:83]
    v_mfma_f32_32x32x16_bf16 v[84:99], v[104:107], v[124:127], v[84:99]
    s_waitcnt lgkmcnt(0)
    v_mfma_f32_32x32x16_bf16 v[4:19], v[128:131], v[108:111], v[4:19]
    ds_read_b128 v[100:103], v156 offset:0
    ds_read_b64_tr_b16 v[116:117], v169 offset:28672
    v_mfma_f32_32x32x16_bf16 v[20:35], v[132:135], v[108:111], v[20:35]
    ds_read_b64_tr_b16 v[118:119], v169 offset:30208
    ds_read_b64_tr_b16 v[120:121], v170 offset:28672
    v_mfma_f32_32x32x16_bf16 v[36:51], v[108:111], v[136:139], v[36:51]
    ds_read_b64_tr_b16 v[122:123], v170 offset:30208
    ds_read_b64_tr_b16 v[124:125], v171 offset:28672
    v_mfma_f32_32x32x16_bf16 v[52:67], v[128:131], v[112:115], v[52:67]
    ds_read_b64_tr_b16 v[126:127], v171 offset:30208
    ds_read_b128 v[104:107], v156 offset:4096
    v_mfma_f32_32x32x16_bf16 v[68:83], v[132:135], v[112:115], v[68:83]
    v_mfma_f32_32x32x16_bf16 v[84:99], v[112:115], v[136:139], v[84:99]
    s_waitcnt lgkmcnt(0)
    v_mfma_f32_32x32x16_bf16 v[4:19], v[116:119], v[100:103], v[4:19]
    ds_read_b128 v[108:111], v157 offset:0
    ds_read_b64_tr_b16 v[128:129], v169 offset:34816
    v_mfma_f32_32x32x16_bf16 v[20:35], v[120:123], v[100:103], v[20:35]
    ds_read_b64_tr_b16 v[130:131], v169 offset:36352
    ds_read_b64_tr_b16 v[132:133], v170 offset:34816
    v_mfma_f32_32x32x16_bf16 v[36:51], v[100:103], v[124:127], v[36:51]
    ds_read_b64_tr_b16 v[134:135], v170 offset:36352
    ds_read_b64_tr_b16 v[136:137], v171 offset:34816
    v_mfma_f32_32x32x16_bf16 v[52:67], v[116:119], v[104:107], v[52:67]
    ds_read_b64_tr_b16 v[138:139], v171 offset:36352
    ds_read_b128 v[112:115], v157 offset:4096
    v_mfma_f32_32x32x16_bf16 v[68:83], v[120:123], v[104:107], v[68:83]
    v_mfma_f32_32x32x16_bf16 v[84:99], v[104:107], v[124:127], v[84:99]
    s_waitcnt lgkmcnt(0)
    s_barrier
    v_mfma_f32_32x32x16_bf16 v[4:19], v[128:131], v[108:111], v[4:19]
    ds_read_b128 v[100:103], v158 offset:0
    ds_read_b64_tr_b16 v[116:117], v172 offset:16384
    v_mfma_f32_32x32x16_bf16 v[20:35], v[132:135], v[108:111], v[20:35]
    ds_read_b64_tr_b16 v[118:119], v172 offset:17920
    ds_read_b64_tr_b16 v[120:121], v173 offset:16384
    v_mfma_f32_32x32x16_bf16 v[36:51], v[108:111], v[136:139], v[36:51]
    ds_read_b64_tr_b16 v[122:123], v173 offset:17920
    ds_read_b64_tr_b16 v[124:125], v174 offset:16384
    v_mfma_f32_32x32x16_bf16 v[52:67], v[128:131], v[112:115], v[52:67]
    ds_read_b64_tr_b16 v[126:127], v174 offset:17920
    ds_read_b128 v[104:107], v158 offset:4096
    v_mfma_f32_32x32x16_bf16 v[68:83], v[132:135], v[112:115], v[68:83]
    v_mfma_f32_32x32x16_bf16 v[84:99], v[112:115], v[136:139], v[84:99]
    s_waitcnt lgkmcnt(0)
    v_mfma_f32_32x32x16_bf16 v[4:19], v[116:119], v[100:103], v[4:19]
    ds_read_b128 v[108:111], v159 offset:0
    ds_read_b64_tr_b16 v[128:129], v172 offset:22528
    v_mfma_f32_32x32x16_bf16 v[20:35], v[120:123], v[100:103], v[20:35]
    ds_read_b64_tr_b16 v[130:131], v172 offset:24064
    ds_read_b64_tr_b16 v[132:133], v173 offset:22528
    v_mfma_f32_32x32x16_bf16 v[36:51], v[100:103], v[124:127], v[36:51]
    ds_read_b64_tr_b16 v[134:135], v173 offset:24064
    ds_read_b64_tr_b16 v[136:137], v174 offset:22528
    v_mfma_f32_32x32x16_bf16 v[52:67], v[116:119], v[104:107], v[52:67]
    ds_read_b64_tr_b16 v[138:139], v174 offset:24064
    ds_read_b128 v[112:115], v159 offset:4096
    v_mfma_f32_32x32x16_bf16 v[68:83], v[120:123], v[104:107], v[68:83]
    v_mfma_f32_32x32x16_bf16 v[84:99], v[104:107], v[124:127], v[84:99]
    s_waitcnt lgkmcnt(0)
    v_mfma_f32_32x32x16_bf16 v[4:19], v[128:131], v[108:111], v[4:19]
    ds_read_b128 v[100:103], v160 offset:0
    ds_read_b64_tr_b16 v[116:117], v172 offset:28672
    v_mfma_f32_32x32x16_bf16 v[20:35], v[132:135], v[108:111], v[20:35]
    ds_read_b64_tr_b16 v[118:119], v172 offset:30208
    ds_read_b64_tr_b16 v[120:121], v173 offset:28672
    v_mfma_f32_32x32x16_bf16 v[36:51], v[108:111], v[136:139], v[36:51]
    ds_read_b64_tr_b16 v[122:123], v173 offset:30208
    ds_read_b64_tr_b16 v[124:125], v174 offset:28672
    v_mfma_f32_32x32x16_bf16 v[52:67], v[128:131], v[112:115], v[52:67]
    ds_read_b64_tr_b16 v[126:127], v174 offset:30208
    ds_read_b128 v[104:107], v160 offset:4096
    v_mfma_f32_32x32x16_bf16 v[68:83], v[132:135], v[112:115], v[68:83]
    v_mfma_f32_32x32x16_bf16 v[84:99], v[112:115], v[136:139], v[84:99]
    s_waitcnt lgkmcnt(0)
    v_mfma_f32_32x32x16_bf16 v[4:19], v[116:119], v[100:103], v[4:19]
    ds_read_b128 v[108:111], v161 offset:0
    ds_read_b64_tr_b16 v[128:129], v172 offset:34816
    v_mfma_f32_32x32x16_bf16 v[20:35], v[120:123], v[100:103], v[20:35]
    ds_read_b64_tr_b16 v[130:131], v172 offset:36352
    ds_read_b64_tr_b16 v[132:133], v173 offset:34816
    v_mfma_f32_32x32x16_bf16 v[36:51], v[100:103], v[124:127], v[36:51]
    ds_read_b64_tr_b16 v[134:135], v173 offset:36352
    ds_read_b64_tr_b16 v[136:137], v174 offset:34816
    v_mfma_f32_32x32x16_bf16 v[52:67], v[116:119], v[104:107], v[52:67]
    ds_read_b64_tr_b16 v[138:139], v174 offset:36352
    ds_read_b128 v[112:115], v161 offset:4096
    v_mfma_f32_32x32x16_bf16 v[68:83], v[120:123], v[104:107], v[68:83]
    v_mfma_f32_32x32x16_bf16 v[84:99], v[104:107], v[124:127], v[84:99]
    s_waitcnt lgkmcnt(0)
    s_barrier
    v_mfma_f32_32x32x16_bf16 v[4:19], v[128:131], v[108:111], v[4:19]
    ds_read_b128 v[100:103], v162 offset:0
    ds_read_b64_tr_b16 v[116:117], v175 offset:16384
    v_mfma_f32_32x32x16_bf16 v[20:35], v[132:135], v[108:111], v[20:35]
    ds_read_b64_tr_b16 v[118:119], v175 offset:17920
    ds_read_b64_tr_b16 v[120:121], v176 offset:16384
    v_mfma_f32_32x32x16_bf16 v[36:51], v[108:111], v[136:139], v[36:51]
    ds_read_b64_tr_b16 v[122:123], v176 offset:17920
    ds_read_b64_tr_b16 v[124:125], v177 offset:16384
    v_mfma_f32_32x32x16_bf16 v[52:67], v[128:131], v[112:115], v[52:67]
    ds_read_b64_tr_b16 v[126:127], v177 offset:17920
    ds_read_b128 v[104:107], v162 offset:4096
    v_mfma_f32_32x32x16_bf16 v[68:83], v[132:135], v[112:115], v[68:83]
    v_mfma_f32_32x32x16_bf16 v[84:99], v[112:115], v[136:139], v[84:99]
    s_waitcnt lgkmcnt(0)
    v_mfma_f32_32x32x16_bf16 v[4:19], v[116:119], v[100:103], v[4:19]
    ds_read_b128 v[108:111], v163 offset:0
    ds_read_b64_tr_b16 v[128:129], v175 offset:22528
    v_mfma_f32_32x32x16_bf16 v[20:35], v[120:123], v[100:103], v[20:35]
    ds_read_b64_tr_b16 v[130:131], v175 offset:24064
    ds_read_b64_tr_b16 v[132:133], v176 offset:22528
    v_mfma_f32_32x32x16_bf16 v[36:51], v[100:103], v[124:127], v[36:51]
    ds_read_b64_tr_b16 v[134:135], v176 offset:24064
    ds_read_b64_tr_b16 v[136:137], v177 offset:22528
    v_mfma_f32_32x32x16_bf16 v[52:67], v[116:119], v[104:107], v[52:67]
    ds_read_b64_tr_b16 v[138:139], v177 offset:24064
    ds_read_b128 v[112:115], v163 offset:4096
    v_mfma_f32_32x32x16_bf16 v[68:83], v[120:123], v[104:107], v[68:83]
    v_mfma_f32_32x32x16_bf16 v[84:99], v[104:107], v[124:127], v[84:99]
    s_waitcnt lgkmcnt(0)
    v_mfma_f32_32x32x16_bf16 v[4:19], v[128:131], v[108:111], v[4:19]
    ds_read_b128 v[100:103], v164 offset:0
    ds_read_b64_tr_b16 v[116:117], v175 offset:28672
    v_mfma_f32_32x32x16_bf16 v[20:35], v[132:135], v[108:111], v[20:35]
    ds_read_b64_tr_b16 v[118:119], v175 offset:30208
    ds_read_b64_tr_b16 v[120:121], v176 offset:28672
    v_mfma_f32_32x32x16_bf16 v[36:51], v[108:111], v[136:139], v[36:51]
    ds_read_b64_tr_b16 v[122:123], v176 offset:30208
    ds_read_b64_tr_b16 v[124:125], v177 offset:28672
    v_mfma_f32_32x32x16_bf16 v[52:67], v[128:131], v[112:115], v[52:67]
    ds_read_b64_tr_b16 v[126:127], v177 offset:30208
    ds_read_b128 v[104:107], v164 offset:4096
    v_mfma_f32_32x32x16_bf16 v[68:83], v[132:135], v[112:115], v[68:83]
    v_mfma_f32_32x32x16_bf16 v[84:99], v[112:115], v[136:139], v[84:99]
    s_waitcnt lgkmcnt(0)
    v_mfma_f32_32x32x16_bf16 v[4:19], v[116:119], v[100:103], v[4:19]
    ds_read_b128 v[108:111], v165 offset:0
    ds_read_b64_tr_b16 v[128:129], v175 offset:34816
    v_mfma_f32_32x32x16_bf16 v[20:35], v[120:123], v[100:103], v[20:35]
    ds_read_b64_tr_b16 v[130:131], v175 offset:36352
    ds_read_b64_tr_b16 v[132:133], v176 offset:34816
    v_mfma_f32_32x32x16_bf16 v[36:51], v[100:103], v[124:127], v[36:51]
    ds_read_b64_tr_b16 v[134:135], v176 offset:36352
    ds_read_b64_tr_b16 v[136:137], v177 offset:34816
    v_mfma_f32_32x32x16_bf16 v[52:67], v[116:119], v[104:107], v[52:67]
    ds_read_b64_tr_b16 v[138:139], v177 offset:36352
    ds_read_b128 v[112:115], v165 offset:4096
    v_mfma_f32_32x32x16_bf16 v[68:83], v[120:123], v[104:107], v[68:83]
    v_mfma_f32_32x32x16_bf16 v[84:99], v[104:107], v[124:127], v[84:99]
    s_waitcnt lgkmcnt(0)
    v_mfma_f32_32x32x16_bf16 v[4:19], v[128:131], v[108:111], v[4:19]
    v_mfma_f32_32x32x16_bf16 v[20:35], v[132:135], v[108:111], v[20:35]
    v_mfma_f32_32x32x16_bf16 v[36:51], v[108:111], v[136:139], v[36:51]
    v_mfma_f32_32x32x16_bf16 v[52:67], v[128:131], v[112:115], v[52:67]
    v_mfma_f32_32x32x16_bf16 v[68:83], v[132:135], v[112:115], v[68:83]
    v_mfma_f32_32x32x16_bf16 v[84:99], v[112:115], v[136:139], v[84:99]
    s_add_u32 s75, s74, 0x400000
    s_nop 7
    s_nop 3
    v_cvt_pk_bf16_f32 v188, v36, v37
    v_cvt_pk_bf16_f32 v189, v38, v39
    v_cvt_pk_bf16_f32 v190, v40, v41
    v_cvt_pk_bf16_f32 v191, v42, v43
    buffer_store_dwordx4 v[188:191], v185, s[12:15], s75 offen offset:0 sc1
    v_cvt_pk_bf16_f32 v192, v44, v45
    v_cvt_pk_bf16_f32 v193, v46, v47
    v_cvt_pk_bf16_f32 v194, v48, v49
    v_cvt_pk_bf16_f32 v195, v50, v51
    buffer_store_dwordx4 v[192:195], v185, s[12:15], s75 offen offset:512 sc1
    v_cvt_pk_bf16_f32 v188, v84, v85
    v_cvt_pk_bf16_f32 v189, v86, v87
    v_cvt_pk_bf16_f32 v190, v88, v89
    v_cvt_pk_bf16_f32 v191, v90, v91
    buffer_store_dwordx4 v[188:191], v185, s[12:15], s75 offen offset:1024 sc1
    v_cvt_pk_bf16_f32 v192, v92, v93
    v_cvt_pk_bf16_f32 v193, v94, v95
    v_cvt_pk_bf16_f32 v194, v96, v97
    v_cvt_pk_bf16_f32 v195, v98, v99
    buffer_store_dwordx4 v[192:195], v185, s[12:15], s75 offen offset:1536 sc1
    s_add_u32 s75, s74, 0x200000
    v_cvt_pk_bf16_f32 v188, v20, v21
    v_cvt_pk_bf16_f32 v189, v22, v23
    v_cvt_pk_bf16_f32 v190, v24, v25
    v_cvt_pk_bf16_f32 v191, v26, v27
    buffer_store_dwordx4 v[188:191], v184, s[12:15], s75 offen offset:0 sc1
    v_mul_f32 v196, v20, v20
    v_fmac_f32 v196, v21, v21
    v_fmac_f32 v196, v22, v22
    v_fmac_f32 v196, v23, v23
    v_fmac_f32 v196, v24, v24
    v_fmac_f32 v196, v25, v25
    v_fmac_f32 v196, v26, v26
    v_fmac_f32 v196, v27, v27
    v_cvt_pk_bf16_f32 v192, v68, v69
    v_cvt_pk_bf16_f32 v193, v70, v71
    v_cvt_pk_bf16_f32 v194, v72, v73
    v_cvt_pk_bf16_f32 v195, v74, v75
    buffer_store_dwordx4 v[192:195], v184, s[12:15], s75 offen offset:1024 sc1
    v_mul_f32 v198, v68, v68
    v_fmac_f32 v198, v69, v69
    v_fmac_f32 v198, v70, v70
    v_fmac_f32 v198, v71, v71
    v_fmac_f32 v198, v72, v72
    v_fmac_f32 v198, v73, v73
    v_fmac_f32 v198, v74, v74
    v_fmac_f32 v198, v75, v75
    s_add_u32 s75, s74, 0x210000
    v_cvt_pk_bf16_f32 v188, v28, v29
    v_cvt_pk_bf16_f32 v189, v30, v31
    v_cvt_pk_bf16_f32 v190, v32, v33
    v_cvt_pk_bf16_f32 v191, v34, v35
    buffer_store_dwordx4 v[188:191], v184, s[12:15], s75 offen offset:0 sc1
    v_mul_f32 v197, v28, v28
    v_fmac_f32 v197, v29, v29
    v_fmac_f32 v197, v30, v30
    v_fmac_f32 v197, v31, v31
    v_fmac_f32 v197, v32, v32
    v_fmac_f32 v197, v33, v33
    v_fmac_f32 v197, v34, v34
    v_fmac_f32 v197, v35, v35
    v_cvt_pk_bf16_f32 v192, v76, v77
    v_cvt_pk_bf16_f32 v193, v78, v79
    v_cvt_pk_bf16_f32 v194, v80, v81
    v_cvt_pk_bf16_f32 v195, v82, v83
    buffer_store_dwordx4 v[192:195], v184, s[12:15], s75 offen offset:1024 sc1
    v_mul_f32 v199, v76, v76
    v_fmac_f32 v199, v77, v77
    v_fmac_f32 v199, v78, v78
    v_fmac_f32 v199, v79, v79
    v_fmac_f32 v199, v80, v80
    v_fmac_f32 v199, v81, v81
    v_fmac_f32 v199, v82, v82
    v_fmac_f32 v199, v83, v83
    s_add_u32 s75, s74, 0x0
    v_mul_f32 v4, 0x3eb8aa3b, v4
    v_mul_f32 v5, 0x3eb8aa3b, v5
    v_mul_f32 v6, 0x3eb8aa3b, v6
    v_mul_f32 v7, 0x3eb8aa3b, v7
    v_mul_f32 v8, 0x3eb8aa3b, v8
    v_mul_f32 v9, 0x3eb8aa3b, v9
    v_mul_f32 v10, 0x3eb8aa3b, v10
    v_mul_f32 v11, 0x3eb8aa3b, v11
    v_cvt_pk_bf16_f32 v188, v4, v5
    v_cvt_pk_bf16_f32 v189, v6, v7
    v_cvt_pk_bf16_f32 v190, v8, v9
    v_cvt_pk_bf16_f32 v191, v10, v11
    buffer_store_dwordx4 v[188:191], v184, s[12:15], s75 offen offset:0 sc1
    v_mul_f32 v52, 0x3eb8aa3b, v52
    v_mul_f32 v53, 0x3eb8aa3b, v53
    v_mul_f32 v54, 0x3eb8aa3b, v54
    v_mul_f32 v55, 0x3eb8aa3b, v55
    v_mul_f32 v56, 0x3eb8aa3b, v56
    v_mul_f32 v57, 0x3eb8aa3b, v57
    v_mul_f32 v58, 0x3eb8aa3b, v58
    v_mul_f32 v59, 0x3eb8aa3b, v59
    v_cvt_pk_bf16_f32 v192, v52, v53
    v_cvt_pk_bf16_f32 v193, v54, v55
    v_cvt_pk_bf16_f32 v194, v56, v57
    v_cvt_pk_bf16_f32 v195, v58, v59
    buffer_store_dwordx4 v[192:195], v184, s[12:15], s75 offen offset:1024 sc1
    s_add_u32 s75, s74, 0x10000
    v_mul_f32 v12, 0x3eb8aa3b, v12
    v_mul_f32 v13, 0x3eb8aa3b, v13
    v_mul_f32 v14, 0x3eb8aa3b, v14
    v_mul_f32 v15, 0x3eb8aa3b, v15
    v_mul_f32 v16, 0x3eb8aa3b, v16
    v_mul_f32 v17, 0x3eb8aa3b, v17
    v_mul_f32 v18, 0x3eb8aa3b, v18
    v_mul_f32 v19, 0x3eb8aa3b, v19
    v_cvt_pk_bf16_f32 v188, v12, v13
    v_cvt_pk_bf16_f32 v189, v14, v15
    v_cvt_pk_bf16_f32 v190, v16, v17
    v_cvt_pk_bf16_f32 v191, v18, v19
    buffer_store_dwordx4 v[188:191], v184, s[12:15], s75 offen offset:0 sc1
    v_mul_f32 v60, 0x3eb8aa3b, v60
    v_mul_f32 v61, 0x3eb8aa3b, v61
    v_mul_f32 v62, 0x3eb8aa3b, v62
    v_mul_f32 v63, 0x3eb8aa3b, v63
    v_mul_f32 v64, 0x3eb8aa3b, v64
    v_mul_f32 v65, 0x3eb8aa3b, v65
    v_mul_f32 v66, 0x3eb8aa3b, v66
    v_mul_f32 v67, 0x3eb8aa3b, v67
    v_cvt_pk_bf16_f32 v192, v60, v61
    v_cvt_pk_bf16_f32 v193, v62, v63
    v_cvt_pk_bf16_f32 v194, v64, v65
    v_cvt_pk_bf16_f32 v195, v66, v67
    buffer_store_dwordx4 v[192:195], v184, s[12:15], s75 offen offset:1024 sc1
    v_permlane32_swap_b32 v196, v198
    v_permlane32_swap_b32 v197, v199
    s_nop 1
    v_add_f32 v196, v196, v198
    v_add_f32 v197, v197, v199
    s_nop 1
    v_max_f32_dpp v196, v196, v196 row_shr:1 row_mask:0xf bank_mask:0xf
    v_max_f32_dpp v197, v197, v197 row_shr:1 row_mask:0xf bank_mask:0xf
    s_nop 1
    v_max_f32_dpp v196, v196, v196 row_shr:2 row_mask:0xf bank_mask:0xf
    v_max_f32_dpp v197, v197, v197 row_shr:2 row_mask:0xf bank_mask:0xf
    s_nop 1
    v_max_f32_dpp v196, v196, v196 row_shr:4 row_mask:0xf bank_mask:0xf
    v_max_f32_dpp v197, v197, v197 row_shr:4 row_mask:0xf bank_mask:0xf
    s_nop 1
    v_max_f32_dpp v196, v196, v196 row_shr:8 row_mask:0xf bank_mask:0xf
    v_max_f32_dpp v197, v197, v197 row_shr:8 row_mask:0xf bank_mask:0xf
    s_nop 1
    v_max_f32_dpp v196, v196, v196 row_bcast:15 row_mask:0xa bank_mask:0xf
    v_max_f32_dpp v197, v197, v197 row_bcast:15 row_mask:0xa bank_mask:0xf
    s_nop 1
    v_max_f32_dpp v196, v196, v196 row_bcast:31 row_mask:0xc bank_mask:0xf
    v_max_f32_dpp v197, v197, v197 row_bcast:31 row_mask:0xc bank_mask:0xf
    s_lshl_b32 s75, s70, 1
    s_add_u32 s75, s75, s37
    s_lshl_b32 s75, s75, 7
    s_lshl_b32 s39, s71, 4
    s_add_u32 s75, s75, s39
    s_lshl_b32 s39, s38, 3
    s_add_u32 s75, s75, s39
    v_mov_b32 v184, 0
    s_mov_b32 s66, 0
    s_mov_b32 s67, 0x80000000
    s_mov_b64 exec, s[66:67]
    buffer_store_dwordx2 v[196:197], v184, s[16:19], s75 offen
    s_branch L_g1_kernel_fin
L_g1_w1:
    s_mov_b32 s8, s48
    s_mov_b32 s9, s49
    s_mov_b32 s10, 0x80000
    s_mov_b32 s11, 0x20000
    s_add_u32 s12, s62, 0x600000
    s_addc_u32 s13, s63, 0
    s_mov_b32 s14, 0x200000
    s_mov_b32 s15, 0x20000
    s_cmp_lt_u32 s34, 4
    s_cbranch_scc1 L_g1_w1_c
    s_mul_i32 s28, s69, 4096
    s_mul_i32 s29, s69, 2048
    s_add_u32 s29, s29, 16384
    v_lshrrev_b32 v84, 3, v1
    v_mul_u32_u24 v85, 32, v3
    v_add3_u32 v84, v84, v85, s32
    v_lshrrev_b32 v85, 4, v1
    v_and_b32 v86, 7, v1
    v_xor_b32 v87, v86, v85
    v_xor_b32 v88, 4, v87
    v_lshlrev_b32 v87, 4, v87
    v_lshlrev_b32 v88, 4, v88
    s_mov_b32 s30, 1024
    v_mul_lo_u32 v89, v84, s30
    v_add_u32 v60, v89, v87
    v_add_u32 v61, v89, v88
    v_add_u32 v61, 0x2000, v61
    v_add_u32 v62, v89, v87
    v_add_u32 v62, 0x4000, v62
    v_add_u32 v63, v89, v88
    v_add_u32 v63, 0x6000, v63
    v_lshrrev_b32 v84, 3, v1
    v_mul_u32_u24 v85, 16, v3
    v_add_u32 v84, v84, v85
    v_and_b32 v86, 7, v1
    v_lshrrev_b32 v85, 4, v1
    v_and_b32 v85, 1, v85
    v_lshlrev_b32 v85, 2, v85
    v_xor_b32 v86, v86, v85
    v_lshlrev_b32 v86, 4, v86
    s_lshl_b32 s30, s33, 1
    v_add_u32 v86, s30, v86
    s_mov_b32 s30, 1024
    v_mul_lo_u32 v89, v84, s30
    v_add_u32 v64, v89, v86
    v_add_u32 v65, v89, v86
    v_add_u32 v65, 0x2000, v65
    v_subrev_u32 v61, 1024, v61
    v_subrev_u32 v62, 2048, v62
    v_subrev_u32 v63, 3072, v63
    v_subrev_u32 v65, 1024, v65
    s_lshl_b32 s82, s35, 4
    s_add_u32 s82, s82, s36
    s_sub_u32 s82, s82, 16
    s_and_b32 s39, s82, 3
    s_lshr_b32 s82, s82, 2
    s_cmp_eq_u32 s39, 0
    s_cselect_b32 s82, s82, 99
    s_mul_i32 s30, s79, 0x80
    s_add_u32 m0, s28, 0x0
    s_nop 0
    buffer_load_dwordx4 v60, s[4:7], s30 offen offset:0 lds
    buffer_load_dwordx4 v61, s[4:7], s30 offen offset:1024 lds
    buffer_load_dwordx4 v62, s[4:7], s30 offen offset:2048 lds
    buffer_load_dwordx4 v63, s[4:7], s30 offen offset:3072 lds
    s_mul_i32 s31, s79, 0x10000
    s_add_u32 m0, s29, 0x0
    s_nop 0
    buffer_load_dwordx4 v64, s[8:11], s31 offen offset:0 lds
    buffer_load_dwordx4 v65, s[8:11], s31 offen offset:1024 lds
    s_add_u32 s30, s30, 0x80
    s_cmp_eq_u32 s30, 0x400
    s_cselect_b32 s30, 0x0, s30
    s_add_u32 m0, s28, 0x6000
    s_nop 0
    buffer_load_dwordx4 v60, s[4:7], s30 offen offset:0 lds
    buffer_load_dwordx4 v61, s[4:7], s30 offen offset:1024 lds
    buffer_load_dwordx4 v62, s[4:7], s30 offen offset:2048 lds
    buffer_load_dwordx4 v63, s[4:7], s30 offen offset:3072 lds
    s_add_u32 s31, s31, 0x10000
    s_cmp_eq_u32 s31, 0x80000
    s_cselect_b32 s31, 0x0, s31
    s_add_u32 m0, s29, 0x6000
    s_nop 0
    buffer_load_dwordx4 v64, s[8:11], s31 offen offset:0 lds
    buffer_load_dwordx4 v65, s[8:11], s31 offen offset:1024 lds
    s_waitcnt vmcnt(6)
    s_barrier
    s_add_u32 s30, s30, 0x80
    s_cmp_eq_u32 s30, 0x400
    s_cselect_b32 s30, 0x0, s30
    s_add_u32 m0, s28, 0xc000
    s_nop 0
    buffer_load_dwordx4 v60, s[4:7], s30 offen offset:0 lds
    buffer_load_dwordx4 v61, s[4:7], s30 offen offset:1024 lds
    buffer_load_dwordx4 v62, s[4:7], s30 offen offset:2048 lds
    buffer_load_dwordx4 v63, s[4:7], s30 offen offset:3072 lds
    s_add_u32 s31, s31, 0x10000
    s_cmp_eq_u32 s31, 0x80000
    s_cselect_b32 s31, 0x0, s31
    s_add_u32 m0, s29, 0xc000
    s_nop 0
    buffer_load_dwordx4 v64, s[8:11], s31 offen offset:0 lds
    buffer_load_dwordx4 v65, s[8:11], s31 offen offset:1024 lds
    s_add_u32 s30, s30, 0x80
    s_cmp_eq_u32 s30, 0x400
    s_cselect_b32 s30, 0x0, s30
    s_add_u32 m0, s28, 0x12000
    s_nop 0
    buffer_load_dwordx4 v60, s[4:7], s30 offen offset:0 lds
    buffer_load_dwordx4 v61, s[4:7], s30 offen offset:1024 lds
    buffer_load_dwordx4 v62, s[4:7], s30 offen offset:2048 lds
    buffer_load_dwordx4 v63, s[4:7], s30 offen offset:3072 lds
    s_add_u32 s31, s31, 0x10000
    s_cmp_eq_u32 s31, 0x80000
    s_cselect_b32 s31, 0x0, s31
    s_add_u32 m0, s29, 0x12000
    s_nop 0
    buffer_load_dwordx4 v64, s[8:11], s31 offen offset:0 lds
    buffer_load_dwordx4 v65, s[8:11], s31 offen offset:1024 lds
    s_waitcnt vmcnt(12)
    s_barrier
    s_add_u32 s30, s30, 0x80
    s_cmp_eq_u32 s30, 0x400
    s_cselect_b32 s30, 0x0, s30
    s_add_u32 m0, s28, 0x0
    s_nop 0
    buffer_load_dwordx4 v60, s[4:7], s30 offen offset:0 lds
    buffer_load_dwordx4 v61, s[4:7], s30 offen offset:1024 lds
    buffer_load_dwordx4 v62, s[4:7], s30 offen offset:2048 lds
    buffer_load_dwordx4 v63, s[4:7], s30 offen offset:3072 lds
    s_add_u32 s31, s31, 0x10000
    s_cmp_eq_u32 s31, 0x80000
    s_cselect_b32 s31, 0x0, s31
    s_add_u32 m0, s29, 0x0
    s_nop 0
    buffer_load_dwordx4 v64, s[8:11], s31 offen offset:0 lds
    buffer_load_dwordx4 v65, s[8:11], s31 offen offset:1024 lds
    s_waitcnt vmcnt(12)
    s_barrier
    s_add_u32 s30, s30, 0x80
    s_cmp_eq_u32 s30, 0x400
    s_cselect_b32 s30, 0x0, s30
    s_add_u32 m0, s28, 0x6000
    s_nop 0
    buffer_load_dwordx4 v60, s[4:7], s30 offen offset:0 lds
    buffer_load_dwordx4 v61, s[4:7], s30 offen offset:1024 lds
    buffer_load_dwordx4 v62, s[4:7], s30 offen offset:2048 lds
    buffer_load_dwordx4 v63, s[4:7], s30 offen offset:3072 lds
    s_add_u32 s31, s31, 0x10000
    s_cmp_eq_u32 s31, 0x80000
    s_cselect_b32 s31, 0x0, s31
    s_add_u32 m0, s29, 0x6000
    s_nop 0
    buffer_load_dwordx4 v64, s[8:11], s31 offen offset:0 lds
    buffer_load_dwordx4 v65, s[8:11], s31 offen offset:1024 lds
    s_waitcnt vmcnt(12)
    s_barrier
    s_add_u32 s30, s30, 0x80
    s_cmp_eq_u32 s30, 0x400
    s_cselect_b32 s30, 0x0, s30
    s_add_u32 m0, s28, 0xc000
    s_nop 0
    buffer_load_dwordx4 v60, s[4:7], s30 offen offset:0 lds
    buffer_load_dwordx4 v61, s[4:7], s30 offen offset:1024 lds
    buffer_load_dwordx4 v62, s[4:7], s30 offen offset:2048 lds
    buffer_load_dwordx4 v63, s[4:7], s30 offen offset:3072 lds
    s_add_u32 s31, s31, 0x10000
    s_cmp_eq_u32 s31, 0x80000
    s_cselect_b32 s31, 0x0, s31
    s_add_u32 m0, s29, 0xc000
    s_nop 0
    buffer_load_dwordx4 v64, s[8:11], s31 offen offset:0 lds
    buffer_load_dwordx4 v65, s[8:11], s31 offen offset:1024 lds
    s_waitcnt vmcnt(12)
    s_barrier
    s_add_u32 s30, s30, 0x80
    s_cmp_eq_u32 s30, 0x400
    s_cselect_b32 s30, 0x0, s30
    s_add_u32 m0, s28, 0x12000
    s_nop 0
    buffer_load_dwordx4 v60, s[4:7], s30 offen offset:0 lds
    buffer_load_dwordx4 v61, s[4:7], s30 offen offset:1024 lds
    buffer_load_dwordx4 v62, s[4:7], s30 offen offset:2048 lds
    buffer_load_dwordx4 v63, s[4:7], s30 offen offset:3072 lds
    s_add_u32 s31, s31, 0x10000
    s_cmp_eq_u32 s31, 0x80000
    s_cselect_b32 s31, 0x0, s31
    s_add_u32 m0, s29, 0x12000
    s_nop 0
    buffer_load_dwordx4 v64, s[8:11], s31 offen offset:0 lds
    buffer_load_dwordx4 v65, s[8:11], s31 offen offset:1024 lds
    s_mov_b32 s20, s52
    s_mov_b32 s21, s53
    s_mov_b32 s22, 0x1c0000
    s_mov_b32 s23, 0x20000
    v_bfe_u32 v160, v0, 3, 5
    v_mul_u32_u24 v160, 3584, v160
    v_and_b32 v84, 7, v0
    v_lshl_add_u32 v160, v84, 4, v160
    s_lshl_b32 s83, s82, 7
    v_add_u32 v160, s83, v160
    s_cmp_lt_u32 s82, 28
    s_cselect_b32 s22, 0x1c0000, 0
    s_mov_b32 s83, 0
    buffer_load_dwordx4 v[96:99], v160, s[20:23], s83 offen
    s_add_u32 s83, s83, 114688
    buffer_load_dwordx4 v[100:103], v160, s[20:23], s83 offen
    s_add_u32 s83, s83, 114688
    buffer_load_dwordx4 v[104:107], v160, s[20:23], s83 offen
    s_add_u32 s83, s83, 114688
    buffer_load_dwordx4 v[108:111], v160, s[20:23], s83 offen
    s_add_u32 s83, s83, 114688
    buffer_load_dwordx4 v[112:115], v160, s[20:23], s83 offen
    s_add_u32 s83, s83, 114688
    buffer_load_dwordx4 v[116:119], v160, s[20:23], s83 offen
    s_add_u32 s83, s83, 114688
    buffer_load_dwordx4 v[120:123], v160, s[20:23], s83 offen
    s_add_u32 s83, s83, 114688
    buffer_load_dwordx4 v[124:127], v160, s[20:23], s83 offen
    s_add_u32 s83, s83, 114688
    buffer_load_dwordx4 v[128:131], v160, s[20:23], s83 offen
    s_add_u32 s83, s83, 114688
    buffer_load_dwordx4 v[132:135], v160, s[20:23], s83 offen
    s_add_u32 s83, s83, 114688
    buffer_load_dwordx4 v[136:139], v160, s[20:23], s83 offen
    s_add_u32 s83, s83, 114688
    buffer_load_dwordx4 v[140:143], v160, s[20:23], s83 offen
    s_add_u32 s83, s83, 114688
    buffer_load_dwordx4 v[144:147], v160, s[20:23], s83 offen
    s_add_u32 s83, s83, 114688
    buffer_load_dwordx4 v[148:151], v160, s[20:23], s83 offen
    s_add_u32 s83, s83, 114688
    buffer_load_dwordx4 v[152:155], v160, s[20:23], s83 offen
    s_add_u32 s83, s83, 114688
    buffer_load_dwordx4 v[156:159], v160, s[20:23], s83 offen
    s_add_u32 s83, s83, 114688
    s_waitcnt vmcnt(28)
    s_barrier
    s_waitcnt vmcnt(22)
    s_barrier
    s_waitcnt vmcnt(16)
    s_barrier
    v_mov_b32 v4, 0
    v_mov_b32 v5, 0
    v_mov_b32 v6, 0
    v_mov_b32 v7, 0
    v_mov_b32 v8, 0
    v_mov_b32 v9, 0
    v_mov_b32 v10, 0
    v_mov_b32 v11, 0
    s_waitcnt vmcnt(15)
    v_lshlrev_b32 v85, 16, v96
    v_and_b32 v86, 0xffff0000, v96
    v_add_f32 v4, v4, v85
    v_add_f32 v5, v5, v86
    v_lshlrev_b32 v85, 16, v97
    v_and_b32 v86, 0xffff0000, v97
    v_add_f32 v6, v6, v85
    v_add_f32 v7, v7, v86
    v_lshlrev_b32 v85, 16, v98
    v_and_b32 v86, 0xffff0000, v98
    v_add_f32 v8, v8, v85
    v_add_f32 v9, v9, v86
    v_lshlrev_b32 v85, 16, v99
    v_and_b32 v86, 0xffff0000, v99
    v_add_f32 v10, v10, v85
    v_add_f32 v11, v11, v86
    s_waitcnt vmcnt(14)
    v_lshlrev_b32 v85, 16, v100
    v_and_b32 v86, 0xffff0000, v100
    v_add_f32 v4, v4, v85
    v_add_f32 v5, v5, v86
    v_lshlrev_b32 v85, 16, v101
    v_and_b32 v86, 0xffff0000, v101
    v_add_f32 v6, v6, v85
    v_add_f32 v7, v7, v86
    v_lshlrev_b32 v85, 16, v102
    v_and_b32 v86, 0xffff0000, v102
    v_add_f32 v8, v8, v85
    v_add_f32 v9, v9, v86
    v_lshlrev_b32 v85, 16, v103
    v_and_b32 v86, 0xffff0000, v103
    v_add_f32 v10, v10, v85
    v_add_f32 v11, v11, v86
    s_waitcnt vmcnt(13)
    v_lshlrev_b32 v85, 16, v104
    v_and_b32 v86, 0xffff0000, v104
    v_add_f32 v4, v4, v85
    v_add_f32 v5, v5, v86
    v_lshlrev_b32 v85, 16, v105
    v_and_b32 v86, 0xffff0000, v105
    v_add_f32 v6, v6, v85
    v_add_f32 v7, v7, v86
    v_lshlrev_b32 v85, 16, v106
    v_and_b32 v86, 0xffff0000, v106
    v_add_f32 v8, v8, v85
    v_add_f32 v9, v9, v86
    v_lshlrev_b32 v85, 16, v107
    v_and_b32 v86, 0xffff0000, v107
    v_add_f32 v10, v10, v85
    v_add_f32 v11, v11, v86
    s_waitcnt vmcnt(12)
    v_lshlrev_b32 v85, 16, v108
    v_and_b32 v86, 0xffff0000, v108
    v_add_f32 v4, v4, v85
    v_add_f32 v5, v5, v86
    v_lshlrev_b32 v85, 16, v109
    v_and_b32 v86, 0xffff0000, v109
    v_add_f32 v6, v6, v85
    v_add_f32 v7, v7, v86
    v_lshlrev_b32 v85, 16, v110
    v_and_b32 v86, 0xffff0000, v110
    v_add_f32 v8, v8, v85
    v_add_f32 v9, v9, v86
    v_lshlrev_b32 v85, 16, v111
    v_and_b32 v86, 0xffff0000, v111
    v_add_f32 v10, v10, v85
    v_add_f32 v11, v11, v86
    s_waitcnt vmcnt(11)
    v_lshlrev_b32 v85, 16, v112
    v_and_b32 v86, 0xffff0000, v112
    v_add_f32 v4, v4, v85
    v_add_f32 v5, v5, v86
    v_lshlrev_b32 v85, 16, v113
    v_and_b32 v86, 0xffff0000, v113
    v_add_f32 v6, v6, v85
    v_add_f32 v7, v7, v86
    v_lshlrev_b32 v85, 16, v114
    v_and_b32 v86, 0xffff0000, v114
    v_add_f32 v8, v8, v85
    v_add_f32 v9, v9, v86
    v_lshlrev_b32 v85, 16, v115
    v_and_b32 v86, 0xffff0000, v115
    v_add_f32 v10, v10, v85
    v_add_f32 v11, v11, v86
    s_waitcnt vmcnt(10)
    v_lshlrev_b32 v85, 16, v116
    v_and_b32 v86, 0xffff0000, v116
    v_add_f32 v4, v4, v85
    v_add_f32 v5, v5, v86
    v_lshlrev_b32 v85, 16, v117
    v_and_b32 v86, 0xffff0000, v117
    v_add_f32 v6, v6, v85
    v_add_f32 v7, v7, v86
    v_lshlrev_b32 v85, 16, v118
    v_and_b32 v86, 0xffff0000, v118
    v_add_f32 v8, v8, v85
    v_add_f32 v9, v9, v86
    v_lshlrev_b32 v85, 16, v119
    v_and_b32 v86, 0xffff0000, v119
    v_add_f32 v10, v10, v85
    v_add_f32 v11, v11, v86
    s_waitcnt vmcnt(9)
    v_lshlrev_b32 v85, 16, v120
    v_and_b32 v86, 0xffff0000, v120
    v_add_f32 v4, v4, v85
    v_add_f32 v5, v5, v86
    v_lshlrev_b32 v85, 16, v121
    v_and_b32 v86, 0xffff0000, v121
    v_add_f32 v6, v6, v85
    v_add_f32 v7, v7, v86
    v_lshlrev_b32 v85, 16, v122
    v_and_b32 v86, 0xffff0000, v122
    v_add_f32 v8, v8, v85
    v_add_f32 v9, v9, v86
    v_lshlrev_b32 v85, 16, v123
    v_and_b32 v86, 0xffff0000, v123
    v_add_f32 v10, v10, v85
    v_add_f32 v11, v11, v86
    s_waitcnt vmcnt(8)
    v_lshlrev_b32 v85, 16, v124
    v_and_b32 v86, 0xffff0000, v124
    v_add_f32 v4, v4, v85
    v_add_f32 v5, v5, v86
    v_lshlrev_b32 v85, 16, v125
    v_and_b32 v86, 0xffff0000, v125
    v_add_f32 v6, v6, v85
    v_add_f32 v7, v7, v86
    v_lshlrev_b32 v85, 16, v126
    v_and_b32 v86, 0xffff0000, v126
    v_add_f32 v8, v8, v85
    v_add_f32 v9, v9, v86
    v_lshlrev_b32 v85, 16, v127
    v_and_b32 v86, 0xffff0000, v127
    v_add_f32 v10, v10, v85
    v_add_f32 v11, v11, v86
    s_waitcnt vmcnt(7)
    v_lshlrev_b32 v85, 16, v128
    v_and_b32 v86, 0xffff0000, v128
    v_add_f32 v4, v4, v85
    v_add_f32 v5, v5, v86
    v_lshlrev_b32 v85, 16, v129
    v_and_b32 v86, 0xffff0000, v129
    v_add_f32 v6, v6, v85
    v_add_f32 v7, v7, v86
    v_lshlrev_b32 v85, 16, v130
    v_and_b32 v86, 0xffff0000, v130
    v_add_f32 v8, v8, v85
    v_add_f32 v9, v9, v86
    v_lshlrev_b32 v85, 16, v131
    v_and_b32 v86, 0xffff0000, v131
    v_add_f32 v10, v10, v85
    v_add_f32 v11, v11, v86
    s_waitcnt vmcnt(6)
    v_lshlrev_b32 v85, 16, v132
    v_and_b32 v86, 0xffff0000, v132
    v_add_f32 v4, v4, v85
    v_add_f32 v5, v5, v86
    v_lshlrev_b32 v85, 16, v133
    v_and_b32 v86, 0xffff0000, v133
    v_add_f32 v6, v6, v85
    v_add_f32 v7, v7, v86
    v_lshlrev_b32 v85, 16, v134
    v_and_b32 v86, 0xffff0000, v134
    v_add_f32 v8, v8, v85
    v_add_f32 v9, v9, v86
    v_lshlrev_b32 v85, 16, v135
    v_and_b32 v86, 0xffff0000, v135
    v_add_f32 v10, v10, v85
    v_add_f32 v11, v11, v86
    s_waitcnt vmcnt(5)
    v_lshlrev_b32 v85, 16, v136
    v_and_b32 v86, 0xffff0000, v136
    v_add_f32 v4, v4, v85
    v_add_f32 v5, v5, v86
    v_lshlrev_b32 v85, 16, v137
    v_and_b32 v86, 0xffff0000, v137
    v_add_f32 v6, v6, v85
    v_add_f32 v7, v7, v86
    v_lshlrev_b32 v85, 16, v138
    v_and_b32 v86, 0xffff0000, v138
    v_add_f32 v8, v8, v85
    v_add_f32 v9, v9, v86
    v_lshlrev_b32 v85, 16, v139
    v_and_b32 v86, 0xffff0000, v139
    v_add_f32 v10, v10, v85
    v_add_f32 v11, v11, v86
    s_waitcnt vmcnt(4)
    v_lshlrev_b32 v85, 16, v140
    v_and_b32 v86, 0xffff0000, v140
    v_add_f32 v4, v4, v85
    v_add_f32 v5, v5, v86
    v_lshlrev_b32 v85, 16, v141
    v_and_b32 v86, 0xffff0000, v141
    v_add_f32 v6, v6, v85
    v_add_f32 v7, v7, v86
    v_lshlrev_b32 v85, 16, v142
    v_and_b32 v86, 0xffff0000, v142
    v_add_f32 v8, v8, v85
    v_add_f32 v9, v9, v86
    v_lshlrev_b32 v85, 16, v143
    v_and_b32 v86, 0xffff0000, v143
    v_add_f32 v10, v10, v85
    v_add_f32 v11, v11, v86
    s_waitcnt vmcnt(3)
    v_lshlrev_b32 v85, 16, v144
    v_and_b32 v86, 0xffff0000, v144
    v_add_f32 v4, v4, v85
    v_add_f32 v5, v5, v86
    v_lshlrev_b32 v85, 16, v145
    v_and_b32 v86, 0xffff0000, v145
    v_add_f32 v6, v6, v85
    v_add_f32 v7, v7, v86
    v_lshlrev_b32 v85, 16, v146
    v_and_b32 v86, 0xffff0000, v146
    v_add_f32 v8, v8, v85
    v_add_f32 v9, v9, v86
    v_lshlrev_b32 v85, 16, v147
    v_and_b32 v86, 0xffff0000, v147
    v_add_f32 v10, v10, v85
    v_add_f32 v11, v11, v86
    s_waitcnt vmcnt(2)
    v_lshlrev_b32 v85, 16, v148
    v_and_b32 v86, 0xffff0000, v148
    v_add_f32 v4, v4, v85
    v_add_f32 v5, v5, v86
    v_lshlrev_b32 v85, 16, v149
    v_and_b32 v86, 0xffff0000, v149
    v_add_f32 v6, v6, v85
    v_add_f32 v7, v7, v86
    v_lshlrev_b32 v85, 16, v150
    v_and_b32 v86, 0xffff0000, v150
    v_add_f32 v8, v8, v85
    v_add_f32 v9, v9, v86
    v_lshlrev_b32 v85, 16, v151
    v_and_b32 v86, 0xffff0000, v151
    v_add_f32 v10, v10, v85
    v_add_f32 v11, v11, v86
    s_waitcnt vmcnt(1)
    v_lshlrev_b32 v85, 16, v152
    v_and_b32 v86, 0xffff0000, v152
    v_add_f32 v4, v4, v85
    v_add_f32 v5, v5, v86
    v_lshlrev_b32 v85, 16, v153
    v_and_b32 v86, 0xffff0000, v153
    v_add_f32 v6, v6, v85
    v_add_f32 v7, v7, v86
    v_lshlrev_b32 v85, 16, v154
    v_and_b32 v86, 0xffff0000, v154
    v_add_f32 v8, v8, v85
    v_add_f32 v9, v9, v86
    v_lshlrev_b32 v85, 16, v155
    v_and_b32 v86, 0xffff0000, v155
    v_add_f32 v10, v10, v85
    v_add_f32 v11, v11, v86
    s_waitcnt vmcnt(0)
    v_lshlrev_b32 v85, 16, v156
    v_and_b32 v86, 0xffff0000, v156
    v_add_f32 v4, v4, v85
    v_add_f32 v5, v5, v86
    v_lshlrev_b32 v85, 16, v157
    v_and_b32 v86, 0xffff0000, v157
    v_add_f32 v6, v6, v85
    v_add_f32 v7, v7, v86
    v_lshlrev_b32 v85, 16, v158
    v_and_b32 v86, 0xffff0000, v158
    v_add_f32 v8, v8, v85
    v_add_f32 v9, v9, v86
    v_lshlrev_b32 v85, 16, v159
    v_and_b32 v86, 0xffff0000, v159
    v_add_f32 v10, v10, v85
    v_add_f32 v11, v11, v86
    v_and_b32 v84, 255, v0
    v_lshlrev_b32 v84, 5, v84
    v_add_u32 v84, 100352, v84
    ds_write_b128 v84, v[4:7]
    ds_write_b128 v84, v[8:11] offset:16
    s_mov_b32 s4, s50
    s_mov_b32 s5, s51
    s_mov_b32 s6, 0x80000
    s_mov_b32 s7, 0x20000
    s_and_b32 s64, s36, 15
    s_lshl_b32 s64, s64, 2
    s_add_u32 s64, s64, s69
    s_lshl_b32 s64, s64, 13
    v_lshlrev_b32 v87, 4, v1
    buffer_load_dwordx4 v[164:167], v87, s[4:7], s64 offen offset:0
    buffer_load_dwordx4 v[164:167], v87, s[4:7], s64 offen offset:1024
    buffer_load_dwordx4 v[164:167], v87, s[4:7], s64 offen offset:2048
    buffer_load_dwordx4 v[164:167], v87, s[4:7], s64 offen offset:3072
    s_add_u32 s64, s64, 4096
    buffer_load_dwordx4 v[164:167], v87, s[4:7], s64 offen offset:0
    buffer_load_dwordx4 v[164:167], v87, s[4:7], s64 offen offset:1024
    buffer_load_dwordx4 v[164:167], v87, s[4:7], s64 offen offset:2048
    buffer_load_dwordx4 v[164:167], v87, s[4:7], s64 offen offset:3072
    s_waitcnt lgkmcnt(0)
    s_barrier
    s_cmp_lg_u32 s34, 4
    s_cbranch_scc1 L_g1_kernel_fin
    s_cmp_lt_u32 s82, 28
    s_cbranch_scc1 L_g1_cs
    s_cmp_lg_u32 s82, 31
    s_cbranch_scc1 L_g1_kernel_fin
    s_add_u32 s12, s62, 0x13a0000
    s_addc_u32 s13, s63, 0
    s_mov_b32 s14, 0x1000
    s_mov_b32 s15, 0x20000
    v_mov_b32 v96, 0
    v_mov_b32 v97, 0
    v_mov_b32 v98, 0
    v_mov_b32 v99, 0
    buffer_store_dwordx4 v[96:99], v87, s[12:15], 0 offen offset:0
    buffer_store_dwordx4 v[96:99], v87, s[12:15], 0 offen offset:1024
    buffer_store_dwordx4 v[96:99], v87, s[12:15], 0 offen offset:2048
    buffer_store_dwordx4 v[96:99], v87, s[12:15], 0 offen offset:3072
    s_branch L_g1_kernel_fin
L_g1_cs:
    s_add_u32 s12, s62, 0x1390000
    s_addc_u32 s13, s63, 0
    s_mov_b32 s14, 0x1c00
    s_mov_b32 s15, 0x20000
    v_lshlrev_b32 v84, 2, v1
    v_add_u32 v85, 100352, v84
    ds_read_b32 v96, v85 offset:0
    ds_read_b32 v97, v85 offset:256
    ds_read_b32 v98, v85 offset:512
    ds_read_b32 v99, v85 offset:768
    ds_read_b32 v100, v85 offset:1024
    ds_read_b32 v101, v85 offset:1280
    ds_read_b32 v102, v85 offset:1536
    ds_read_b32 v103, v85 offset:1792
    s_waitcnt lgkmcnt(0)
    ds_read_b32 v104, v85 offset:2048
    ds_read_b32 v105, v85 offset:2304
    ds_read_b32 v106, v85 offset:2560
    ds_read_b32 v107, v85 offset:2816
    ds_read_b32 v108, v85 offset:3072
    ds_read_b32 v109, v85 offset:3328
    ds_read_b32 v110, v85 offset:3584
    ds_read_b32 v111, v85 offset:3840
    s_waitcnt lgkmcnt(0)
    ds_read_b32 v112, v85 offset:4096
    ds_read_b32 v113, v85 offset:4352
    ds_read_b32 v114, v85 offset:4608
    ds_read_b32 v115, v85 offset:4864
    ds_read_b32 v116, v85 offset:5120
    ds_read_b32 v117, v85 offset:5376
    ds_read_b32 v118, v85 offset:5632
    ds_read_b32 v119, v85 offset:5888
    s_waitcnt lgkmcnt(0)
    ds_read_b32 v120, v85 offset:6144
    ds_read_b32 v121, v85 offset:6400
    ds_read_b32 v122, v85 offset:6656
    ds_read_b32 v123, v85 offset:6912
    ds_read_b32 v124, v85 offset:7168
    ds_read_b32 v125, v85 offset:7424
    ds_read_b32 v126, v85 offset:7680
    ds_read_b32 v127, v85 offset:7936
    s_waitcnt lgkmcnt(0)
    v_add_f32 v96, v96, v97
    v_add_f32 v96, v96, v98
    v_add_f32 v96, v96, v99
    v_add_f32 v96, v96, v100
    v_add_f32 v96, v96, v101
    v_add_f32 v96, v96, v102
    v_add_f32 v96, v96, v103
    v_add_f32 v96, v96, v104
    v_add_f32 v96, v96, v105
    v_add_f32 v96, v96, v106
    v_add_f32 v96, v96, v107
    v_add_f32 v96, v96, v108
    v_add_f32 v96, v96, v109
    v_add_f32 v96, v96, v110
    v_add_f32 v96, v96, v111
    v_add_f32 v96, v96, v112
    v_add_f32 v96, v96, v113
    v_add_f32 v96, v96, v114
    v_add_f32 v96, v96, v115
    v_add_f32 v96, v96, v116
    v_add_f32 v96, v96, v117
    v_add_f32 v96, v96, v118
    v_add_f32 v96, v96, v119
    v_add_f32 v96, v96, v120
    v_add_f32 v96, v96, v121
    v_add_f32 v96, v96, v122
    v_add_f32 v96, v96, v123
    v_add_f32 v96, v96, v124
    v_add_f32 v96, v96, v125
    v_add_f32 v96, v96, v126
    v_add_f32 v96, v96, v127
    s_lshl_b32 s68, s82, 8
    buffer_store_dword v96, v84, s[12:15], s68 offen
    s_branch L_g1_kernel_fin
L_g1_w1_c:
    v_lshrrev_b32 v84, 1, v2
    v_and_b32 v85, 1, v2
    v_and_b32 v86, 31, v1
    v_lshrrev_b32 v87, 5, v1
    v_mul_u32_u24 v88, 8192, v84
    v_lshl_add_u32 v88, v86, 7, v88
    v_bfe_u32 v89, v1, 1, 3
    v_xor_b32 v89, v89, v87
    v_xor_b32 v66, 0, v89
    v_lshl_add_u32 v66, v66, 4, v88
    v_xor_b32 v86, 0, v85
    v_lshl_add_u32 v66, v86, 12, v66
    v_add_u32 v74, 0xc000, v66
    v_xor_b32 v67, 0, v89
    v_lshl_add_u32 v67, v67, 4, v88
    v_xor_b32 v86, 1, v85
    v_lshl_add_u32 v67, v86, 12, v67
    v_add_u32 v75, 0xc000, v67
    v_xor_b32 v68, 2, v89
    v_lshl_add_u32 v68, v68, 4, v88
    v_xor_b32 v86, 0, v85
    v_lshl_add_u32 v68, v86, 12, v68
    v_add_u32 v76, 0xc000, v68
    v_xor_b32 v69, 2, v89
    v_lshl_add_u32 v69, v69, 4, v88
    v_xor_b32 v86, 1, v85
    v_lshl_add_u32 v69, v86, 12, v69
    v_add_u32 v77, 0xc000, v69
    v_xor_b32 v70, 4, v89
    v_lshl_add_u32 v70, v70, 4, v88
    v_xor_b32 v86, 0, v85
    v_lshl_add_u32 v70, v86, 12, v70
    v_add_u32 v78, 0xc000, v70
    v_xor_b32 v71, 4, v89
    v_lshl_add_u32 v71, v71, 4, v88
    v_xor_b32 v86, 1, v85
    v_lshl_add_u32 v71, v86, 12, v71
    v_add_u32 v79, 0xc000, v71
    v_xor_b32 v72, 6, v89
    v_lshl_add_u32 v72, v72, 4, v88
    v_xor_b32 v86, 0, v85
    v_lshl_add_u32 v72, v86, 12, v72
    v_add_u32 v80, 0xc000, v72
    v_xor_b32 v73, 6, v89
    v_lshl_add_u32 v73, v73, 4, v88
    v_xor_b32 v86, 1, v85
    v_lshl_add_u32 v73, v86, 12, v73
    v_add_u32 v81, 0xc000, v73
    v_bfe_u32 v86, v1, 2, 2
    v_lshl_add_u32 v88, v87, 3, v86
    v_mul_u32_u24 v88, 128, v88
    v_and_b32 v89, 1, v1
    v_lshl_add_u32 v88, v89, 3, v88
    v_lshrrev_b32 v86, 1, v86
    v_lshlrev_b32 v86, 2, v86
    v_bfe_u32 v89, v1, 4, 1
    v_lshlrev_b32 v89, 1, v89
    v_bfe_u32 v87, v1, 1, 1
    v_add_u32 v89, v89, v87
    v_mul_u32_u24 v87, 4, v85
    v_add_u32 v89, v89, v87
    v_add_u32 v82, 0, v89
    v_xor_b32 v82, v82, v86
    v_lshl_add_u32 v82, v82, 4, v88
    v_add_u32 v83, 0xc000, v82
    v_mov_b32 v90, 0
    v_mov_b32 v91, 0
    v_mov_b32 v92, 0
    v_mov_b32 v94, 0x3f803f80
    s_barrier
    ds_read_b128 v[36:39], v66 offset:0
    ds_read_b64_tr_b16 v[52:53], v82 offset:16384
    ds_read_b64_tr_b16 v[54:55], v82 offset:16896
    ds_read_b128 v[40:43], v67 offset:0
    s_waitcnt lgkmcnt(0)
    v_mfma_f32_32x32x16_bf16 v[4:19], v[52:55], v[36:39], 0
    ds_read_b128 v[44:47], v68 offset:0
    ds_read_b64_tr_b16 v[56:57], v82 offset:18432
    ds_read_b64_tr_b16 v[58:59], v82 offset:18944
    ds_read_b128 v[48:51], v69 offset:0
    v_mfma_f32_32x32x16_bf16 v[20:35], v[52:55], v[40:43], 0
    v_dot2c_f32_bf16 v91, v36, v36
    v_dot2c_f32_bf16 v90, v36, v94
    v_dot2c_f32_bf16 v92, v52, v94
    v_dot2c_f32_bf16 v91, v37, v37
    v_dot2c_f32_bf16 v90, v37, v94
    v_dot2c_f32_bf16 v92, v53, v94
    v_dot2c_f32_bf16 v91, v38, v38
    v_dot2c_f32_bf16 v90, v38, v94
    v_dot2c_f32_bf16 v92, v54, v94
    v_dot2c_f32_bf16 v91, v39, v39
    v_dot2c_f32_bf16 v90, v39, v94
    v_dot2c_f32_bf16 v92, v55, v94
    s_waitcnt lgkmcnt(0)
    v_mfma_f32_32x32x16_bf16 v[4:19], v[56:59], v[44:47], v[4:19]
    ds_read_b128 v[36:39], v70 offset:0
    ds_read_b64_tr_b16 v[52:53], v82 offset:20480
    ds_read_b64_tr_b16 v[54:55], v82 offset:20992
    ds_read_b128 v[40:43], v71 offset:0
    v_mfma_f32_32x32x16_bf16 v[20:35], v[56:59], v[48:51], v[20:35]
    v_dot2c_f32_bf16 v91, v44, v44
    v_dot2c_f32_bf16 v90, v44, v94
    v_dot2c_f32_bf16 v92, v56, v94
    v_dot2c_f32_bf16 v91, v45, v45
    v_dot2c_f32_bf16 v90, v45, v94
    v_dot2c_f32_bf16 v92, v57, v94
    v_dot2c_f32_bf16 v91, v46, v46
    v_dot2c_f32_bf16 v90, v46, v94
    v_dot2c_f32_bf16 v92, v58, v94
    v_dot2c_f32_bf16 v91, v47, v47
    v_dot2c_f32_bf16 v90, v47, v94
    v_dot2c_f32_bf16 v92, v59, v94
    s_waitcnt lgkmcnt(0)
    v_mfma_f32_32x32x16_bf16 v[4:19], v[52:55], v[36:39], v[4:19]
    ds_read_b128 v[44:47], v72 offset:0
    ds_read_b64_tr_b16 v[56:57], v82 offset:22528
    ds_read_b64_tr_b16 v[58:59], v82 offset:23040
    ds_read_b128 v[48:51], v73 offset:0
    v_mfma_f32_32x32x16_bf16 v[20:35], v[52:55], v[40:43], v[20:35]
    v_dot2c_f32_bf16 v91, v36, v36
    v_dot2c_f32_bf16 v90, v36, v94
    v_dot2c_f32_bf16 v92, v52, v94
    v_dot2c_f32_bf16 v91, v37, v37
    v_dot2c_f32_bf16 v90, v37, v94
    v_dot2c_f32_bf16 v92, v53, v94
    v_dot2c_f32_bf16 v91, v38, v38
    v_dot2c_f32_bf16 v90, v38, v94
    v_dot2c_f32_bf16 v92, v54, v94
    v_dot2c_f32_bf16 v91, v39, v39
    v_dot2c_f32_bf16 v90, v39, v94
    v_dot2c_f32_bf16 v92, v55, v94
    s_waitcnt lgkmcnt(0)
    s_barrier
    v_mfma_f32_32x32x16_bf16 v[4:19], v[56:59], v[44:47], v[4:19]
    ds_read_b128 v[36:39], v66 offset:24576
    ds_read_b64_tr_b16 v[52:53], v82 offset:40960
    ds_read_b64_tr_b16 v[54:55], v82 offset:41472
    ds_read_b128 v[40:43], v67 offset:24576
    v_mfma_f32_32x32x16_bf16 v[20:35], v[56:59], v[48:51], v[20:35]
    v_dot2c_f32_bf16 v91, v44, v44
    v_dot2c_f32_bf16 v90, v44, v94
    v_dot2c_f32_bf16 v92, v56, v94
    v_dot2c_f32_bf16 v91, v45, v45
    v_dot2c_f32_bf16 v90, v45, v94
    v_dot2c_f32_bf16 v92, v57, v94
    v_dot2c_f32_bf16 v91, v46, v46
    v_dot2c_f32_bf16 v90, v46, v94
    v_dot2c_f32_bf16 v92, v58, v94
    v_dot2c_f32_bf16 v91, v47, v47
    v_dot2c_f32_bf16 v90, v47, v94
    v_dot2c_f32_bf16 v92, v59, v94
    s_waitcnt lgkmcnt(0)
    v_mfma_f32_32x32x16_bf16 v[4:19], v[52:55], v[36:39], v[4:19]
    ds_read_b128 v[44:47], v68 offset:24576
    ds_read_b64_tr_b16 v[56:57], v82 offset:43008
    ds_read_b64_tr_b16 v[58:59], v82 offset:43520
    ds_read_b128 v[48:51], v69 offset:24576
    v_mfma_f32_32x32x16_bf16 v[20:35], v[52:55], v[40:43], v[20:35]
    v_dot2c_f32_bf16 v91, v36, v36
    v_dot2c_f32_bf16 v90, v36, v94
    v_dot2c_f32_bf16 v92, v52, v94
    v_dot2c_f32_bf16 v91, v37, v37
    v_dot2c_f32_bf16 v90, v37, v94
    v_dot2c_f32_bf16 v92, v53, v94
    v_dot2c_f32_bf16 v91, v38, v38
    v_dot2c_f32_bf16 v90, v38, v94
    v_dot2c_f32_bf16 v92, v54, v94
    v_dot2c_f32_bf16 v91, v39, v39
    v_dot2c_f32_bf16 v90, v39, v94
    v_dot2c_f32_bf16 v92, v55, v94
    s_waitcnt lgkmcnt(0)
    v_mfma_f32_32x32x16_bf16 v[4:19], v[56:59], v[44:47], v[4:19]
    ds_read_b128 v[36:39], v70 offset:24576
    ds_read_b64_tr_b16 v[52:53], v82 offset:45056
    ds_read_b64_tr_b16 v[54:55], v82 offset:45568
    ds_read_b128 v[40:43], v71 offset:24576
    v_mfma_f32_32x32x16_bf16 v[20:35], v[56:59], v[48:51], v[20:35]
    v_dot2c_f32_bf16 v91, v44, v44
    v_dot2c_f32_bf16 v90, v44, v94
    v_dot2c_f32_bf16 v92, v56, v94
    v_dot2c_f32_bf16 v91, v45, v45
    v_dot2c_f32_bf16 v90, v45, v94
    v_dot2c_f32_bf16 v92, v57, v94
    v_dot2c_f32_bf16 v91, v46, v46
    v_dot2c_f32_bf16 v90, v46, v94
    v_dot2c_f32_bf16 v92, v58, v94
    v_dot2c_f32_bf16 v91, v47, v47
    v_dot2c_f32_bf16 v90, v47, v94
    v_dot2c_f32_bf16 v92, v59, v94
    s_waitcnt lgkmcnt(0)
    v_mfma_f32_32x32x16_bf16 v[4:19], v[52:55], v[36:39], v[4:19]
    ds_read_b128 v[44:47], v72 offset:24576
    ds_read_b64_tr_b16 v[56:57], v82 offset:47104
    ds_read_b64_tr_b16 v[58:59], v82 offset:47616
    ds_read_b128 v[48:51], v73 offset:24576
    v_mfma_f32_32x32x16_bf16 v[20:35], v[52:55], v[40:43], v[20:35]
    v_dot2c_f32_bf16 v91, v36, v36
    v_dot2c_f32_bf16 v90, v36, v94
    v_dot2c_f32_bf16 v92, v52, v94
    v_dot2c_f32_bf16 v91, v37, v37
    v_dot2c_f32_bf16 v90, v37, v94
    v_dot2c_f32_bf16 v92, v53, v94
    v_dot2c_f32_bf16 v91, v38, v38
    v_dot2c_f32_bf16 v90, v38, v94
    v_dot2c_f32_bf16 v92, v54, v94
    v_dot2c_f32_bf16 v91, v39, v39
    v_dot2c_f32_bf16 v90, v39, v94
    v_dot2c_f32_bf16 v92, v55, v94
    s_waitcnt lgkmcnt(0)
    s_barrier
    v_mfma_f32_32x32x16_bf16 v[4:19], v[56:59], v[44:47], v[4:19]
    ds_read_b128 v[36:39], v74 offset:0
    ds_read_b64_tr_b16 v[52:53], v83 offset:16384
    ds_read_b64_tr_b16 v[54:55], v83 offset:16896
    ds_read_b128 v[40:43], v75 offset:0
    v_mfma_f32_32x32x16_bf16 v[20:35], v[56:59], v[48:51], v[20:35]
    v_dot2c_f32_bf16 v91, v44, v44
    v_dot2c_f32_bf16 v90, v44, v94
    v_dot2c_f32_bf16 v92, v56, v94
    v_dot2c_f32_bf16 v91, v45, v45
    v_dot2c_f32_bf16 v90, v45, v94
    v_dot2c_f32_bf16 v92, v57, v94
    v_dot2c_f32_bf16 v91, v46, v46
    v_dot2c_f32_bf16 v90, v46, v94
    v_dot2c_f32_bf16 v92, v58, v94
    v_dot2c_f32_bf16 v91, v47, v47
    v_dot2c_f32_bf16 v90, v47, v94
    v_dot2c_f32_bf16 v92, v59, v94
    s_waitcnt lgkmcnt(0)
    v_mfma_f32_32x32x16_bf16 v[4:19], v[52:55], v[36:39], v[4:19]
    ds_read_b128 v[44:47], v76 offset:0
    ds_read_b64_tr_b16 v[56:57], v83 offset:18432
    ds_read_b64_tr_b16 v[58:59], v83 offset:18944
    ds_read_b128 v[48:51], v77 offset:0
    v_mfma_f32_32x32x16_bf16 v[20:35], v[52:55], v[40:43], v[20:35]
    v_dot2c_f32_bf16 v91, v36, v36
    v_dot2c_f32_bf16 v90, v36, v94
    v_dot2c_f32_bf16 v92, v52, v94
    v_dot2c_f32_bf16 v91, v37, v37
    v_dot2c_f32_bf16 v90, v37, v94
    v_dot2c_f32_bf16 v92, v53, v94
    v_dot2c_f32_bf16 v91, v38, v38
    v_dot2c_f32_bf16 v90, v38, v94
    v_dot2c_f32_bf16 v92, v54, v94
    v_dot2c_f32_bf16 v91, v39, v39
    v_dot2c_f32_bf16 v90, v39, v94
    v_dot2c_f32_bf16 v92, v55, v94
    s_waitcnt lgkmcnt(0)
    v_mfma_f32_32x32x16_bf16 v[4:19], v[56:59], v[44:47], v[4:19]
    ds_read_b128 v[36:39], v78 offset:0
    ds_read_b64_tr_b16 v[52:53], v83 offset:20480
    ds_read_b64_tr_b16 v[54:55], v83 offset:20992
    ds_read_b128 v[40:43], v79 offset:0
    v_mfma_f32_32x32x16_bf16 v[20:35], v[56:59], v[48:51], v[20:35]
    v_dot2c_f32_bf16 v91, v44, v44
    v_dot2c_f32_bf16 v90, v44, v94
    v_dot2c_f32_bf16 v92, v56, v94
    v_dot2c_f32_bf16 v91, v45, v45
    v_dot2c_f32_bf16 v90, v45, v94
    v_dot2c_f32_bf16 v92, v57, v94
    v_dot2c_f32_bf16 v91, v46, v46
    v_dot2c_f32_bf16 v90, v46, v94
    v_dot2c_f32_bf16 v92, v58, v94
    v_dot2c_f32_bf16 v91, v47, v47
    v_dot2c_f32_bf16 v90, v47, v94
    v_dot2c_f32_bf16 v92, v59, v94
    s_waitcnt lgkmcnt(0)
    v_mfma_f32_32x32x16_bf16 v[4:19], v[52:55], v[36:39], v[4:19]
    ds_read_b128 v[44:47], v80 offset:0
    ds_read_b64_tr_b16 v[56:57], v83 offset:22528
    ds_read_b64_tr_b16 v[58:59], v83 offset:23040
    ds_read_b128 v[48:51], v81 offset:0
    v_mfma_f32_32x32x16_bf16 v[20:35], v[52:55], v[40:43], v[20:35]
    v_dot2c_f32_bf16 v91, v36, v36
    v_dot2c_f32_bf16 v90, v36, v94
    v_dot2c_f32_bf16 v92, v52, v94
    v_dot2c_f32_bf16 v91, v37, v37
    v_dot2c_f32_bf16 v90, v37, v94
    v_dot2c_f32_bf16 v92, v53, v94
    v_dot2c_f32_bf16 v91, v38, v38
    v_dot2c_f32_bf16 v90, v38, v94
    v_dot2c_f32_bf16 v92, v54, v94
    v_dot2c_f32_bf16 v91, v39, v39
    v_dot2c_f32_bf16 v90, v39, v94
    v_dot2c_f32_bf16 v92, v55, v94
    s_waitcnt lgkmcnt(0)
    s_barrier
    v_mfma_f32_32x32x16_bf16 v[4:19], v[56:59], v[44:47], v[4:19]
    ds_read_b128 v[36:39], v74 offset:24576
    ds_read_b64_tr_b16 v[52:53], v83 offset:40960
    ds_read_b64_tr_b16 v[54:55], v83 offset:41472
    ds_read_b128 v[40:43], v75 offset:24576
    v_mfma_f32_32x32x16_bf16 v[20:35], v[56:59], v[48:51], v[20:35]
    v_dot2c_f32_bf16 v91, v44, v44
    v_dot2c_f32_bf16 v90, v44, v94
    v_dot2c_f32_bf16 v92, v56, v94
    v_dot2c_f32_bf16 v91, v45, v45
    v_dot2c_f32_bf16 v90, v45, v94
    v_dot2c_f32_bf16 v92, v57, v94
    v_dot2c_f32_bf16 v91, v46, v46
    v_dot2c_f32_bf16 v90, v46, v94
    v_dot2c_f32_bf16 v92, v58, v94
    v_dot2c_f32_bf16 v91, v47, v47
    v_dot2c_f32_bf16 v90, v47, v94
    v_dot2c_f32_bf16 v92, v59, v94
    s_waitcnt lgkmcnt(0)
    v_mfma_f32_32x32x16_bf16 v[4:19], v[52:55], v[36:39], v[4:19]
    ds_read_b128 v[44:47], v76 offset:24576
    ds_read_b64_tr_b16 v[56:57], v83 offset:43008
    ds_read_b64_tr_b16 v[58:59], v83 offset:43520
    ds_read_b128 v[48:51], v77 offset:24576
    v_mfma_f32_32x32x16_bf16 v[20:35], v[52:55], v[40:43], v[20:35]
    v_dot2c_f32_bf16 v91, v36, v36
    v_dot2c_f32_bf16 v90, v36, v94
    v_dot2c_f32_bf16 v92, v52, v94
    v_dot2c_f32_bf16 v91, v37, v37
    v_dot2c_f32_bf16 v90, v37, v94
    v_dot2c_f32_bf16 v92, v53, v94
    v_dot2c_f32_bf16 v91, v38, v38
    v_dot2c_f32_bf16 v90, v38, v94
    v_dot2c_f32_bf16 v92, v54, v94
    v_dot2c_f32_bf16 v91, v39, v39
    v_dot2c_f32_bf16 v90, v39, v94
    v_dot2c_f32_bf16 v92, v55, v94
    s_waitcnt lgkmcnt(0)
    v_mfma_f32_32x32x16_bf16 v[4:19], v[56:59], v[44:47], v[4:19]
    ds_read_b128 v[36:39], v78 offset:24576
    ds_read_b64_tr_b16 v[52:53], v83 offset:45056
    ds_read_b64_tr_b16 v[54:55], v83 offset:45568
    ds_read_b128 v[40:43], v79 offset:24576
    v_mfma_f32_32x32x16_bf16 v[20:35], v[56:59], v[48:51], v[20:35]
    v_dot2c_f32_bf16 v91, v44, v44
    v_dot2c_f32_bf16 v90, v44, v94
    v_dot2c_f32_bf16 v92, v56, v94
    v_dot2c_f32_bf16 v91, v45, v45
    v_dot2c_f32_bf16 v90, v45, v94
    v_dot2c_f32_bf16 v92, v57, v94
    v_dot2c_f32_bf16 v91, v46, v46
    v_dot2c_f32_bf16 v90, v46, v94
    v_dot2c_f32_bf16 v92, v58, v94
    v_dot2c_f32_bf16 v91, v47, v47
    v_dot2c_f32_bf16 v90, v47, v94
    v_dot2c_f32_bf16 v92, v59, v94
    s_waitcnt lgkmcnt(0)
    v_mfma_f32_32x32x16_bf16 v[4:19], v[52:55], v[36:39], v[4:19]
    ds_read_b128 v[44:47], v80 offset:24576
    ds_read_b64_tr_b16 v[56:57], v83 offset:47104
    ds_read_b64_tr_b16 v[58:59], v83 offset:47616
    ds_read_b128 v[48:51], v81 offset:24576
    v_mfma_f32_32x32x16_bf16 v[20:35], v[52:55], v[40:43], v[20:35]
    v_dot2c_f32_bf16 v91, v36, v36
    v_dot2c_f32_bf16 v90, v36, v94
    v_dot2c_f32_bf16 v92, v52, v94
    v_dot2c_f32_bf16 v91, v37, v37
    v_dot2c_f32_bf16 v90, v37, v94
    v_dot2c_f32_bf16 v92, v53, v94
    v_dot2c_f32_bf16 v91, v38, v38
    v_dot2c_f32_bf16 v90, v38, v94
    v_dot2c_f32_bf16 v92, v54, v94
    v_dot2c_f32_bf16 v91, v39, v39
    v_dot2c_f32_bf16 v90, v39, v94
    v_dot2c_f32_bf16 v92, v55, v94
    s_waitcnt lgkmcnt(0)
    s_barrier
    v_mfma_f32_32x32x16_bf16 v[4:19], v[56:59], v[44:47], v[4:19]
    ds_read_b128 v[36:39], v66 offset:0
    ds_read_b64_tr_b16 v[52:53], v82 offset:16384
    ds_read_b64_tr_b16 v[54:55], v82 offset:16896
    ds_read_b128 v[40:43], v67 offset:0
    v_mfma_f32_32x32x16_bf16 v[20:35], v[56:59], v[48:51], v[20:35]
    v_dot2c_f32_bf16 v91, v44, v44
    v_dot2c_f32_bf16 v90, v44, v94
    v_dot2c_f32_bf16 v92, v56, v94
    v_dot2c_f32_bf16 v91, v45, v45
    v_dot2c_f32_bf16 v90, v45, v94
    v_dot2c_f32_bf16 v92, v57, v94
    v_dot2c_f32_bf16 v91, v46, v46
    v_dot2c_f32_bf16 v90, v46, v94
    v_dot2c_f32_bf16 v92, v58, v94
    v_dot2c_f32_bf16 v91, v47, v47
    v_dot2c_f32_bf16 v90, v47, v94
    v_dot2c_f32_bf16 v92, v59, v94
    s_waitcnt lgkmcnt(0)
    v_mfma_f32_32x32x16_bf16 v[4:19], v[52:55], v[36:39], v[4:19]
    ds_read_b128 v[44:47], v68 offset:0
    ds_read_b64_tr_b16 v[56:57], v82 offset:18432
    ds_read_b64_tr_b16 v[58:59], v82 offset:18944
    ds_read_b128 v[48:51], v69 offset:0
    v_mfma_f32_32x32x16_bf16 v[20:35], v[52:55], v[40:43], v[20:35]
    v_dot2c_f32_bf16 v91, v36, v36
    v_dot2c_f32_bf16 v90, v36, v94
    v_dot2c_f32_bf16 v92, v52, v94
    v_dot2c_f32_bf16 v91, v37, v37
    v_dot2c_f32_bf16 v90, v37, v94
    v_dot2c_f32_bf16 v92, v53, v94
    v_dot2c_f32_bf16 v91, v38, v38
    v_dot2c_f32_bf16 v90, v38, v94
    v_dot2c_f32_bf16 v92, v54, v94
    v_dot2c_f32_bf16 v91, v39, v39
    v_dot2c_f32_bf16 v90, v39, v94
    v_dot2c_f32_bf16 v92, v55, v94
    s_waitcnt lgkmcnt(0)
    v_mfma_f32_32x32x16_bf16 v[4:19], v[56:59], v[44:47], v[4:19]
    ds_read_b128 v[36:39], v70 offset:0
    ds_read_b64_tr_b16 v[52:53], v82 offset:20480
    ds_read_b64_tr_b16 v[54:55], v82 offset:20992
    ds_read_b128 v[40:43], v71 offset:0
    v_mfma_f32_32x32x16_bf16 v[20:35], v[56:59], v[48:51], v[20:35]
    v_dot2c_f32_bf16 v91, v44, v44
    v_dot2c_f32_bf16 v90, v44, v94
    v_dot2c_f32_bf16 v92, v56, v94
    v_dot2c_f32_bf16 v91, v45, v45
    v_dot2c_f32_bf16 v90, v45, v94
    v_dot2c_f32_bf16 v92, v57, v94
    v_dot2c_f32_bf16 v91, v46, v46
    v_dot2c_f32_bf16 v90, v46, v94
    v_dot2c_f32_bf16 v92, v58, v94
    v_dot2c_f32_bf16 v91, v47, v47
    v_dot2c_f32_bf16 v90, v47, v94
    v_dot2c_f32_bf16 v92, v59, v94
    s_waitcnt lgkmcnt(0)
    v_mfma_f32_32x32x16_bf16 v[4:19], v[52:55], v[36:39], v[4:19]
    ds_read_b128 v[44:47], v72 offset:0
    ds_read_b64_tr_b16 v[56:57], v82 offset:22528
    ds_read_b64_tr_b16 v[58:59], v82 offset:23040
    ds_read_b128 v[48:51], v73 offset:0
    v_mfma_f32_32x32x16_bf16 v[20:35], v[52:55], v[40:43], v[20:35]
    v_dot2c_f32_bf16 v91, v36, v36
    v_dot2c_f32_bf16 v90, v36, v94
    v_dot2c_f32_bf16 v92, v52, v94
    v_dot2c_f32_bf16 v91, v37, v37
    v_dot2c_f32_bf16 v90, v37, v94
    v_dot2c_f32_bf16 v92, v53, v94
    v_dot2c_f32_bf16 v91, v38, v38
    v_dot2c_f32_bf16 v90, v38, v94
    v_dot2c_f32_bf16 v92, v54, v94
    v_dot2c_f32_bf16 v91, v39, v39
    v_dot2c_f32_bf16 v90, v39, v94
    v_dot2c_f32_bf16 v92, v55, v94
    s_waitcnt lgkmcnt(0)
    s_barrier
    v_mfma_f32_32x32x16_bf16 v[4:19], v[56:59], v[44:47], v[4:19]
    ds_read_b128 v[36:39], v66 offset:24576
    ds_read_b64_tr_b16 v[52:53], v82 offset:40960
    ds_read_b64_tr_b16 v[54:55], v82 offset:41472
    ds_read_b128 v[40:43], v67 offset:24576
    v_mfma_f32_32x32x16_bf16 v[20:35], v[56:59], v[48:51], v[20:35]
    v_dot2c_f32_bf16 v91, v44, v44
    v_dot2c_f32_bf16 v90, v44, v94
    v_dot2c_f32_bf16 v92, v56, v94
    v_dot2c_f32_bf16 v91, v45, v45
    v_dot2c_f32_bf16 v90, v45, v94
    v_dot2c_f32_bf16 v92, v57, v94
    v_dot2c_f32_bf16 v91, v46, v46
    v_dot2c_f32_bf16 v90, v46, v94
    v_dot2c_f32_bf16 v92, v58, v94
    v_dot2c_f32_bf16 v91, v47, v47
    v_dot2c_f32_bf16 v90, v47, v94
    v_dot2c_f32_bf16 v92, v59, v94
    s_waitcnt lgkmcnt(0)
    v_mfma_f32_32x32x16_bf16 v[4:19], v[52:55], v[36:39], v[4:19]
    ds_read_b128 v[44:47], v68 offset:24576
    ds_read_b64_tr_b16 v[56:57], v82 offset:43008
    ds_read_b64_tr_b16 v[58:59], v82 offset:43520
    ds_read_b128 v[48:51], v69 offset:24576
    v_mfma_f32_32x32x16_bf16 v[20:35], v[52:55], v[40:43], v[20:35]
    v_dot2c_f32_bf16 v91, v36, v36
    v_dot2c_f32_bf16 v90, v36, v94
    v_dot2c_f32_bf16 v92, v52, v94
    v_dot2c_f32_bf16 v91, v37, v37
    v_dot2c_f32_bf16 v90, v37, v94
    v_dot2c_f32_bf16 v92, v53, v94
    v_dot2c_f32_bf16 v91, v38, v38
    v_dot2c_f32_bf16 v90, v38, v94
    v_dot2c_f32_bf16 v92, v54, v94
    v_dot2c_f32_bf16 v91, v39, v39
    v_dot2c_f32_bf16 v90, v39, v94
    v_dot2c_f32_bf16 v92, v55, v94
    s_waitcnt lgkmcnt(0)
    v_mfma_f32_32x32x16_bf16 v[4:19], v[56:59], v[44:47], v[4:19]
    ds_read_b128 v[36:39], v70 offset:24576
    ds_read_b64_tr_b16 v[52:53], v82 offset:45056
    ds_read_b64_tr_b16 v[54:55], v82 offset:45568
    ds_read_b128 v[40:43], v71 offset:24576
    v_mfma_f32_32x32x16_bf16 v[20:35], v[56:59], v[48:51], v[20:35]
    v_dot2c_f32_bf16 v91, v44, v44
    v_dot2c_f32_bf16 v90, v44, v94
    v_dot2c_f32_bf16 v92, v56, v94
    v_dot2c_f32_bf16 v91, v45, v45
    v_dot2c_f32_bf16 v90, v45, v94
    v_dot2c_f32_bf16 v92, v57, v94
    v_dot2c_f32_bf16 v91, v46, v46
    v_dot2c_f32_bf16 v90, v46, v94
    v_dot2c_f32_bf16 v92, v58, v94
    v_dot2c_f32_bf16 v91, v47, v47
    v_dot2c_f32_bf16 v90, v47, v94
    v_dot2c_f32_bf16 v92, v59, v94
    s_waitcnt lgkmcnt(0)
    v_mfma_f32_32x32x16_bf16 v[4:19], v[52:55], v[36:39], v[4:19]
    ds_read_b128 v[44:47], v72 offset:24576
    ds_read_b64_tr_b16 v[56:57], v82 offset:47104
    ds_read_b64_tr_b16 v[58:59], v82 offset:47616
    ds_read_b128 v[48:51], v73 offset:24576
    v_mfma_f32_32x32x16_bf16 v[20:35], v[52:55], v[40:43], v[20:35]
    v_dot2c_f32_bf16 v91, v36, v36
    v_dot2c_f32_bf16 v90, v36, v94
    v_dot2c_f32_bf16 v92, v52, v94
    v_dot2c_f32_bf16 v91, v37, v37
    v_dot2c_f32_bf16 v90, v37, v94
    v_dot2c_f32_bf16 v92, v53, v94
    v_dot2c_f32_bf16 v91, v38, v38
    v_dot2c_f32_bf16 v90, v38, v94
    v_dot2c_f32_bf16 v92, v54, v94
    v_dot2c_f32_bf16 v91, v39, v39
    v_dot2c_f32_bf16 v90, v39, v94
    v_dot2c_f32_bf16 v92, v55, v94
    s_waitcnt lgkmcnt(0)
    s_barrier
    v_mfma_f32_32x32x16_bf16 v[4:19], v[56:59], v[44:47], v[4:19]
    ds_read_b128 v[36:39], v74 offset:0
    ds_read_b64_tr_b16 v[52:53], v83 offset:16384
    ds_read_b64_tr_b16 v[54:55], v83 offset:16896
    ds_read_b128 v[40:43], v75 offset:0
    v_mfma_f32_32x32x16_bf16 v[20:35], v[56:59], v[48:51], v[20:35]
    v_dot2c_f32_bf16 v91, v44, v44
    v_dot2c_f32_bf16 v90, v44, v94
    v_dot2c_f32_bf16 v92, v56, v94
    v_dot2c_f32_bf16 v91, v45, v45
    v_dot2c_f32_bf16 v90, v45, v94
    v_dot2c_f32_bf16 v92, v57, v94
    v_dot2c_f32_bf16 v91, v46, v46
    v_dot2c_f32_bf16 v90, v46, v94
    v_dot2c_f32_bf16 v92, v58, v94
    v_dot2c_f32_bf16 v91, v47, v47
    v_dot2c_f32_bf16 v90, v47, v94
    v_dot2c_f32_bf16 v92, v59, v94
    s_waitcnt lgkmcnt(0)
    v_mfma_f32_32x32x16_bf16 v[4:19], v[52:55], v[36:39], v[4:19]
    ds_read_b128 v[44:47], v76 offset:0
    ds_read_b64_tr_b16 v[56:57], v83 offset:18432
    ds_read_b64_tr_b16 v[58:59], v83 offset:18944
    ds_read_b128 v[48:51], v77 offset:0
    v_mfma_f32_32x32x16_bf16 v[20:35], v[52:55], v[40:43], v[20:35]
    v_dot2c_f32_bf16 v91, v36, v36
    v_dot2c_f32_bf16 v90, v36, v94
    v_dot2c_f32_bf16 v92, v52, v94
    v_dot2c_f32_bf16 v91, v37, v37
    v_dot2c_f32_bf16 v90, v37, v94
    v_dot2c_f32_bf16 v92, v53, v94
    v_dot2c_f32_bf16 v91, v38, v38
    v_dot2c_f32_bf16 v90, v38, v94
    v_dot2c_f32_bf16 v92, v54, v94
    v_dot2c_f32_bf16 v91, v39, v39
    v_dot2c_f32_bf16 v90, v39, v94
    v_dot2c_f32_bf16 v92, v55, v94
    s_waitcnt lgkmcnt(0)
    v_mfma_f32_32x32x16_bf16 v[4:19], v[56:59], v[44:47], v[4:19]
    ds_read_b128 v[36:39], v78 offset:0
    ds_read_b64_tr_b16 v[52:53], v83 offset:20480
    ds_read_b64_tr_b16 v[54:55], v83 offset:20992
    ds_read_b128 v[40:43], v79 offset:0
    v_mfma_f32_32x32x16_bf16 v[20:35], v[56:59], v[48:51], v[20:35]
    v_dot2c_f32_bf16 v91, v44, v44
    v_dot2c_f32_bf16 v90, v44, v94
    v_dot2c_f32_bf16 v92, v56, v94
    v_dot2c_f32_bf16 v91, v45, v45
    v_dot2c_f32_bf16 v90, v45, v94
    v_dot2c_f32_bf16 v92, v57, v94
    v_dot2c_f32_bf16 v91, v46, v46
    v_dot2c_f32_bf16 v90, v46, v94
    v_dot2c_f32_bf16 v92, v58, v94
    v_dot2c_f32_bf16 v91, v47, v47
    v_dot2c_f32_bf16 v90, v47, v94
    v_dot2c_f32_bf16 v92, v59, v94
    s_waitcnt lgkmcnt(0)
    v_mfma_f32_32x32x16_bf16 v[4:19], v[52:55], v[36:39], v[4:19]
    ds_read_b128 v[44:47], v80 offset:0
    ds_read_b64_tr_b16 v[56:57], v83 offset:22528
    ds_read_b64_tr_b16 v[58:59], v83 offset:23040
    ds_read_b128 v[48:51], v81 offset:0
    v_mfma_f32_32x32x16_bf16 v[20:35], v[52:55], v[40:43], v[20:35]
    v_dot2c_f32_bf16 v91, v36, v36
    v_dot2c_f32_bf16 v90, v36, v94
    v_dot2c_f32_bf16 v92, v52, v94
    v_dot2c_f32_bf16 v91, v37, v37
    v_dot2c_f32_bf16 v90, v37, v94
    v_dot2c_f32_bf16 v92, v53, v94
    v_dot2c_f32_bf16 v91, v38, v38
    v_dot2c_f32_bf16 v90, v38, v94
    v_dot2c_f32_bf16 v92, v54, v94
    v_dot2c_f32_bf16 v91, v39, v39
    v_dot2c_f32_bf16 v90, v39, v94
    v_dot2c_f32_bf16 v92, v55, v94
    s_waitcnt lgkmcnt(0)
    s_barrier
    v_mfma_f32_32x32x16_bf16 v[4:19], v[56:59], v[44:47], v[4:19]
    ds_read_b128 v[36:39], v74 offset:24576
    ds_read_b64_tr_b16 v[52:53], v83 offset:40960
    ds_read_b64_tr_b16 v[54:55], v83 offset:41472
    ds_read_b128 v[40:43], v75 offset:24576
    v_mfma_f32_32x32x16_bf16 v[20:35], v[56:59], v[48:51], v[20:35]
    v_dot2c_f32_bf16 v91, v44, v44
    v_dot2c_f32_bf16 v90, v44, v94
    v_dot2c_f32_bf16 v92, v56, v94
    v_dot2c_f32_bf16 v91, v45, v45
    v_dot2c_f32_bf16 v90, v45, v94
    v_dot2c_f32_bf16 v92, v57, v94
    v_dot2c_f32_bf16 v91, v46, v46
    v_dot2c_f32_bf16 v90, v46, v94
    v_dot2c_f32_bf16 v92, v58, v94
    v_dot2c_f32_bf16 v91, v47, v47
    v_dot2c_f32_bf16 v90, v47, v94
    v_dot2c_f32_bf16 v92, v59, v94
    s_waitcnt lgkmcnt(0)
    v_mfma_f32_32x32x16_bf16 v[4:19], v[52:55], v[36:39], v[4:19]
    ds_read_b128 v[44:47], v76 offset:24576
    ds_read_b64_tr_b16 v[56:57], v83 offset:43008
    ds_read_b64_tr_b16 v[58:59], v83 offset:43520
    ds_read_b128 v[48:51], v77 offset:24576
    v_mfma_f32_32x32x16_bf16 v[20:35], v[52:55], v[40:43], v[20:35]
    v_dot2c_f32_bf16 v91, v36, v36
    v_dot2c_f32_bf16 v90, v36, v94
    v_dot2c_f32_bf16 v92, v52, v94
    v_dot2c_f32_bf16 v91, v37, v37
    v_dot2c_f32_bf16 v90, v37, v94
    v_dot2c_f32_bf16 v92, v53, v94
    v_dot2c_f32_bf16 v91, v38, v38
    v_dot2c_f32_bf16 v90, v38, v94
    v_dot2c_f32_bf16 v92, v54, v94
    v_dot2c_f32_bf16 v91, v39, v39
    v_dot2c_f32_bf16 v90, v39, v94
    v_dot2c_f32_bf16 v92, v55, v94
    s_waitcnt lgkmcnt(0)
    v_mfma_f32_32x32x16_bf16 v[4:19], v[56:59], v[44:47], v[4:19]
    ds_read_b128 v[36:39], v78 offset:24576
    ds_read_b64_tr_b16 v[52:53], v83 offset:45056
    ds_read_b64_tr_b16 v[54:55], v83 offset:45568
    ds_read_b128 v[40:43], v79 offset:24576
    v_mfma_f32_32x32x16_bf16 v[20:35], v[56:59], v[48:51], v[20:35]
    v_dot2c_f32_bf16 v91, v44, v44
    v_dot2c_f32_bf16 v90, v44, v94
    v_dot2c_f32_bf16 v92, v56, v94
    v_dot2c_f32_bf16 v91, v45, v45
    v_dot2c_f32_bf16 v90, v45, v94
    v_dot2c_f32_bf16 v92, v57, v94
    v_dot2c_f32_bf16 v91, v46, v46
    v_dot2c_f32_bf16 v90, v46, v94
    v_dot2c_f32_bf16 v92, v58, v94
    v_dot2c_f32_bf16 v91, v47, v47
    v_dot2c_f32_bf16 v90, v47, v94
    v_dot2c_f32_bf16 v92, v59, v94
    s_waitcnt lgkmcnt(0)
    v_mfma_f32_32x32x16_bf16 v[4:19], v[52:55], v[36:39], v[4:19]
    ds_read_b128 v[44:47], v80 offset:24576
    ds_read_b64_tr_b16 v[56:57], v83 offset:47104
    ds_read_b64_tr_b16 v[58:59], v83 offset:47616
    ds_read_b128 v[48:51], v81 offset:24576
    v_mfma_f32_32x32x16_bf16 v[20:35], v[52:55], v[40:43], v[20:35]
    v_dot2c_f32_bf16 v91, v36, v36
    v_dot2c_f32_bf16 v90, v36, v94
    v_dot2c_f32_bf16 v92, v52, v94
    v_dot2c_f32_bf16 v91, v37, v37
    v_dot2c_f32_bf16 v90, v37, v94
    v_dot2c_f32_bf16 v92, v53, v94
    v_dot2c_f32_bf16 v91, v38, v38
    v_dot2c_f32_bf16 v90, v38, v94
    v_dot2c_f32_bf16 v92, v54, v94
    v_dot2c_f32_bf16 v91, v39, v39
    v_dot2c_f32_bf16 v90, v39, v94
    v_dot2c_f32_bf16 v92, v55, v94
    s_waitcnt lgkmcnt(0)
    v_mfma_f32_32x32x16_bf16 v[4:19], v[56:59], v[44:47], v[4:19]
    v_mfma_f32_32x32x16_bf16 v[20:35], v[56:59], v[48:51], v[20:35]
    v_dot2c_f32_bf16 v91, v44, v44
    v_dot2c_f32_bf16 v90, v44, v94
    v_dot2c_f32_bf16 v92, v56, v94
    v_dot2c_f32_bf16 v91, v45, v45
    v_dot2c_f32_bf16 v90, v45, v94
    v_dot2c_f32_bf16 v92, v57, v94
    v_dot2c_f32_bf16 v91, v46, v46
    v_dot2c_f32_bf16 v90, v46, v94
    v_dot2c_f32_bf16 v92, v58, v94
    v_dot2c_f32_bf16 v91, v47, v47
    v_dot2c_f32_bf16 v90, v47, v94
    v_dot2c_f32_bf16 v92, v59, v94
    s_nop 3
    v_mov_b32 v93, v92
    v_and_b32 v84, 31, v1
    v_lshrrev_b32 v85, 5, v1
    v_permlane32_swap_b32 v90, v91
    v_permlane32_swap_b32 v93, v92
    s_lshl_b32 s39, s37, 8
    s_lshl_b32 s64, s38, 7
    v_add_f32 v90, v90, v91
    v_add_f32 v92, v93, v92
    s_add_u32 s39, s39, s64
    s_add_u32 s39, s39, 98304
    s_add_u32 s64, s64, 99328
    v_lshlrev_b32 v86, 2, v84
    v_lshl_add_u32 v87, v85, 9, v86
    v_add_u32 v87, s39, v87
    ds_write_b32 v87, v90
    v_add_u32 v88, s64, v86
    ds_write_b32 v88, v92
    s_waitcnt lgkmcnt(0)
    s_barrier
    s_xor_b32 s65, s38, 0
    s_lshl_b32 s65, s65, 5
    s_lshl_b32 s66, s37, 6
    s_add_u32 s65, s65, s66
    s_lshl_b32 s66, s65, 2
    s_add_u32 s66, s66, 98304
    v_add_u32 v87, s66, v86
    ds_read_b32 v184, v87
    ds_read_b32 v188, v87 offset:512
    s_add_u32 s65, s65, s32
    s_lshl_b32 s80, s65, 5
    s_xor_b32 s65, s38, 1
    s_lshl_b32 s65, s65, 5
    s_lshl_b32 s66, s37, 6
    s_add_u32 s65, s65, s66
    s_lshl_b32 s66, s65, 2
    s_add_u32 s66, s66, 98304
    v_add_u32 v87, s66, v86
    ds_read_b32 v186, v87
    ds_read_b32 v190, v87 offset:512
    s_add_u32 s65, s65, s32
    s_lshl_b32 s81, s65, 5
    v_lshlrev_b32 v87, 4, v85
    v_add_u32 v87, s64, v87
    ds_read_b128 v[168:171], v87 offset:0
    ds_read_b128 v[172:175], v87 offset:32
    ds_read_b128 v[176:179], v87 offset:64
    ds_read_b128 v[180:183], v87 offset:96
    s_lshl_b32 s68, s38, 5
    s_add_u32 s68, s68, s33
    s_lshl_b32 s68, s68, 12
    v_lshlrev_b32 v192, 4, v1
    s_waitcnt lgkmcnt(0)
    v_mul_f32 v184, 0xbb000000, v184
    v_mul_f32 v188, 0x3b000000, v188
    v_fma_f32 v188, -v184, v184, v188
    v_max_f32 v188, 0, v188
    v_add_f32 v188, 0x3727c5ac, v188
    v_rsq_f32 v188, v188
    v_mul_f32 v186, 0xbb000000, v186
    v_mul_f32 v190, 0x3b000000, v190
    v_fma_f32 v190, -v186, v186, v190
    v_max_f32 v190, 0, v190
    v_add_f32 v190, 0x3727c5ac, v190
    v_rsq_f32 v190, v190
    v_mov_b32 v212, 0xc0135761
    v_mov_b32 v214, 0xbdd2d3e8
    v_mov_b32 v216, 1.0
    v_pk_fma_f32 v[4:5], v[168:169], v[184:185], v[4:5] op_sel_hi:[1,0,1]
    v_pk_fma_f32 v[6:7], v[170:171], v[184:185], v[6:7] op_sel_hi:[1,0,1]
    v_pk_fma_f32 v[8:9], v[172:173], v[184:185], v[8:9] op_sel_hi:[1,0,1]
    v_pk_fma_f32 v[10:11], v[174:175], v[184:185], v[10:11] op_sel_hi:[1,0,1]
    v_pk_mul_f32 v[4:5], v[4:5], v[188:189] op_sel_hi:[1,0]
    v_pk_mul_f32 v[6:7], v[6:7], v[188:189] op_sel_hi:[1,0]
    v_pk_mul_f32 v[8:9], v[8:9], v[188:189] op_sel_hi:[1,0]
    v_pk_mul_f32 v[10:11], v[10:11], v[188:189] op_sel_hi:[1,0]
    v_pk_mul_f32 v[204:205], v[4:5], v[4:5]
    v_pk_mul_f32 v[206:207], v[6:7], v[6:7]
    v_pk_mul_f32 v[208:209], v[8:9], v[8:9]
    v_pk_mul_f32 v[210:211], v[10:11], v[10:11]
    v_pk_fma_f32 v[204:205], v[204:205], v[214:215], v[212:213] op_sel_hi:[1,0,0]
    v_pk_fma_f32 v[206:207], v[206:207], v[214:215], v[212:213] op_sel_hi:[1,0,0]
    v_pk_fma_f32 v[208:209], v[208:209], v[214:215], v[212:213] op_sel_hi:[1,0,0]
    v_pk_fma_f32 v[210:211], v[210:211], v[214:215], v[212:213] op_sel_hi:[1,0,0]
    v_pk_mul_f32 v[204:205], v[204:205], v[4:5]
    v_pk_mul_f32 v[206:207], v[206:207], v[6:7]
    v_pk_mul_f32 v[208:209], v[208:209], v[8:9]
    v_pk_mul_f32 v[210:211], v[210:211], v[10:11]
    v_exp_f32 v204, v204
    v_exp_f32 v206, v206
    v_exp_f32 v208, v208
    v_exp_f32 v210, v210
    v_exp_f32 v205, v205
    v_exp_f32 v207, v207
    v_exp_f32 v209, v209
    v_exp_f32 v211, v211
    v_pk_add_f32 v[204:205], v[204:205], v[216:217] op_sel_hi:[1,0]
    v_pk_add_f32 v[206:207], v[206:207], v[216:217] op_sel_hi:[1,0]
    v_pk_add_f32 v[208:209], v[208:209], v[216:217] op_sel_hi:[1,0]
    v_pk_add_f32 v[210:211], v[210:211], v[216:217] op_sel_hi:[1,0]
    v_rcp_f32 v204, v204
    v_rcp_f32 v206, v206
    v_rcp_f32 v208, v208
    v_rcp_f32 v210, v210
    v_rcp_f32 v205, v205
    v_rcp_f32 v207, v207
    v_rcp_f32 v209, v209
    v_rcp_f32 v211, v211
    v_pk_mul_f32 v[4:5], v[4:5], v[204:205]
    v_pk_mul_f32 v[6:7], v[6:7], v[206:207]
    v_pk_mul_f32 v[8:9], v[8:9], v[208:209]
    v_pk_mul_f32 v[10:11], v[10:11], v[210:211]
    s_add_u32 s64, s80, s68
    v_cvt_pk_bf16_f32 v196, v4, v5
    v_cvt_pk_bf16_f32 v197, v6, v7
    v_cvt_pk_bf16_f32 v198, v8, v9
    v_cvt_pk_bf16_f32 v199, v10, v11
    buffer_store_dwordx4 v[196:199], v192, s[12:15], s64 offen sc1
    v_pk_fma_f32 v[12:13], v[176:177], v[184:185], v[12:13] op_sel_hi:[1,0,1]
    v_pk_fma_f32 v[14:15], v[178:179], v[184:185], v[14:15] op_sel_hi:[1,0,1]
    v_pk_fma_f32 v[16:17], v[180:181], v[184:185], v[16:17] op_sel_hi:[1,0,1]
    v_pk_fma_f32 v[18:19], v[182:183], v[184:185], v[18:19] op_sel_hi:[1,0,1]
    v_pk_mul_f32 v[12:13], v[12:13], v[188:189] op_sel_hi:[1,0]
    v_pk_mul_f32 v[14:15], v[14:15], v[188:189] op_sel_hi:[1,0]
    v_pk_mul_f32 v[16:17], v[16:17], v[188:189] op_sel_hi:[1,0]
    v_pk_mul_f32 v[18:19], v[18:19], v[188:189] op_sel_hi:[1,0]
    v_pk_mul_f32 v[204:205], v[12:13], v[12:13]
    v_pk_mul_f32 v[206:207], v[14:15], v[14:15]
    v_pk_mul_f32 v[208:209], v[16:17], v[16:17]
    v_pk_mul_f32 v[210:211], v[18:19], v[18:19]
    v_pk_fma_f32 v[204:205], v[204:205], v[214:215], v[212:213] op_sel_hi:[1,0,0]
    v_pk_fma_f32 v[206:207], v[206:207], v[214:215], v[212:213] op_sel_hi:[1,0,0]
    v_pk_fma_f32 v[208:209], v[208:209], v[214:215], v[212:213] op_sel_hi:[1,0,0]
    v_pk_fma_f32 v[210:211], v[210:211], v[214:215], v[212:213] op_sel_hi:[1,0,0]
    v_pk_mul_f32 v[204:205], v[204:205], v[12:13]
    v_pk_mul_f32 v[206:207], v[206:207], v[14:15]
    v_pk_mul_f32 v[208:209], v[208:209], v[16:17]
    v_pk_mul_f32 v[210:211], v[210:211], v[18:19]
    v_exp_f32 v204, v204
    v_exp_f32 v206, v206
    v_exp_f32 v208, v208
    v_exp_f32 v210, v210
    v_exp_f32 v205, v205
    v_exp_f32 v207, v207
    v_exp_f32 v209, v209
    v_exp_f32 v211, v211
    v_pk_add_f32 v[204:205], v[204:205], v[216:217] op_sel_hi:[1,0]
    v_pk_add_f32 v[206:207], v[206:207], v[216:217] op_sel_hi:[1,0]
    v_pk_add_f32 v[208:209], v[208:209], v[216:217] op_sel_hi:[1,0]
    v_pk_add_f32 v[210:211], v[210:211], v[216:217] op_sel_hi:[1,0]
    v_rcp_f32 v204, v204
    v_rcp_f32 v206, v206
    v_rcp_f32 v208, v208
    v_rcp_f32 v210, v210
    v_rcp_f32 v205, v205
    v_rcp_f32 v207, v207
    v_rcp_f32 v209, v209
    v_rcp_f32 v211, v211
    v_pk_mul_f32 v[12:13], v[12:13], v[204:205]
    v_pk_mul_f32 v[14:15], v[14:15], v[206:207]
    v_pk_mul_f32 v[16:17], v[16:17], v[208:209]
    v_pk_mul_f32 v[18:19], v[18:19], v[210:211]
    s_add_u32 s64, s64, 0x10000
    v_cvt_pk_bf16_f32 v200, v12, v13
    v_cvt_pk_bf16_f32 v201, v14, v15
    v_cvt_pk_bf16_f32 v202, v16, v17
    v_cvt_pk_bf16_f32 v203, v18, v19
    buffer_store_dwordx4 v[200:203], v192, s[12:15], s64 offen sc1
    v_pk_fma_f32 v[20:21], v[168:169], v[186:187], v[20:21] op_sel_hi:[1,0,1]
    v_pk_fma_f32 v[22:23], v[170:171], v[186:187], v[22:23] op_sel_hi:[1,0,1]
    v_pk_fma_f32 v[24:25], v[172:173], v[186:187], v[24:25] op_sel_hi:[1,0,1]
    v_pk_fma_f32 v[26:27], v[174:175], v[186:187], v[26:27] op_sel_hi:[1,0,1]
    v_pk_mul_f32 v[20:21], v[20:21], v[190:191] op_sel_hi:[1,0]
    v_pk_mul_f32 v[22:23], v[22:23], v[190:191] op_sel_hi:[1,0]
    v_pk_mul_f32 v[24:25], v[24:25], v[190:191] op_sel_hi:[1,0]
    v_pk_mul_f32 v[26:27], v[26:27], v[190:191] op_sel_hi:[1,0]
    v_pk_mul_f32 v[204:205], v[20:21], v[20:21]
    v_pk_mul_f32 v[206:207], v[22:23], v[22:23]
    v_pk_mul_f32 v[208:209], v[24:25], v[24:25]
    v_pk_mul_f32 v[210:211], v[26:27], v[26:27]
    v_pk_fma_f32 v[204:205], v[204:205], v[214:215], v[212:213] op_sel_hi:[1,0,0]
    v_pk_fma_f32 v[206:207], v[206:207], v[214:215], v[212:213] op_sel_hi:[1,0,0]
    v_pk_fma_f32 v[208:209], v[208:209], v[214:215], v[212:213] op_sel_hi:[1,0,0]
    v_pk_fma_f32 v[210:211], v[210:211], v[214:215], v[212:213] op_sel_hi:[1,0,0]
    v_pk_mul_f32 v[204:205], v[204:205], v[20:21]
    v_pk_mul_f32 v[206:207], v[206:207], v[22:23]
    v_pk_mul_f32 v[208:209], v[208:209], v[24:25]
    v_pk_mul_f32 v[210:211], v[210:211], v[26:27]
    v_exp_f32 v204, v204
    v_exp_f32 v206, v206
    v_exp_f32 v208, v208
    v_exp_f32 v210, v210
    v_exp_f32 v205, v205
    v_exp_f32 v207, v207
    v_exp_f32 v209, v209
    v_exp_f32 v211, v211
    v_pk_add_f32 v[204:205], v[204:205], v[216:217] op_sel_hi:[1,0]
    v_pk_add_f32 v[206:207], v[206:207], v[216:217] op_sel_hi:[1,0]
    v_pk_add_f32 v[208:209], v[208:209], v[216:217] op_sel_hi:[1,0]
    v_pk_add_f32 v[210:211], v[210:211], v[216:217] op_sel_hi:[1,0]
    v_rcp_f32 v204, v204
    v_rcp_f32 v206, v206
    v_rcp_f32 v208, v208
    v_rcp_f32 v210, v210
    v_rcp_f32 v205, v205
    v_rcp_f32 v207, v207
    v_rcp_f32 v209, v209
    v_rcp_f32 v211, v211
    v_pk_mul_f32 v[20:21], v[20:21], v[204:205]
    v_pk_mul_f32 v[22:23], v[22:23], v[206:207]
    v_pk_mul_f32 v[24:25], v[24:25], v[208:209]
    v_pk_mul_f32 v[26:27], v[26:27], v[210:211]
    s_add_u32 s64, s81, s68
    v_cvt_pk_bf16_f32 v196, v20, v21
    v_cvt_pk_bf16_f32 v197, v22, v23
    v_cvt_pk_bf16_f32 v198, v24, v25
    v_cvt_pk_bf16_f32 v199, v26, v27
    buffer_store_dwordx4 v[196:199], v192, s[12:15], s64 offen sc1
    v_pk_fma_f32 v[28:29], v[176:177], v[186:187], v[28:29] op_sel_hi:[1,0,1]
    v_pk_fma_f32 v[30:31], v[178:179], v[186:187], v[30:31] op_sel_hi:[1,0,1]
    v_pk_fma_f32 v[32:33], v[180:181], v[186:187], v[32:33] op_sel_hi:[1,0,1]
    v_pk_fma_f32 v[34:35], v[182:183], v[186:187], v[34:35] op_sel_hi:[1,0,1]
    v_pk_mul_f32 v[28:29], v[28:29], v[190:191] op_sel_hi:[1,0]
    v_pk_mul_f32 v[30:31], v[30:31], v[190:191] op_sel_hi:[1,0]
    v_pk_mul_f32 v[32:33], v[32:33], v[190:191] op_sel_hi:[1,0]
    v_pk_mul_f32 v[34:35], v[34:35], v[190:191] op_sel_hi:[1,0]
    v_pk_mul_f32 v[204:205], v[28:29], v[28:29]
    v_pk_mul_f32 v[206:207], v[30:31], v[30:31]
    v_pk_mul_f32 v[208:209], v[32:33], v[32:33]
    v_pk_mul_f32 v[210:211], v[34:35], v[34:35]
    v_pk_fma_f32 v[204:205], v[204:205], v[214:215], v[212:213] op_sel_hi:[1,0,0]
    v_pk_fma_f32 v[206:207], v[206:207], v[214:215], v[212:213] op_sel_hi:[1,0,0]
    v_pk_fma_f32 v[208:209], v[208:209], v[214:215], v[212:213] op_sel_hi:[1,0,0]
    v_pk_fma_f32 v[210:211], v[210:211], v[214:215], v[212:213] op_sel_hi:[1,0,0]
    v_pk_mul_f32 v[204:205], v[204:205], v[28:29]
    v_pk_mul_f32 v[206:207], v[206:207], v[30:31]
    v_pk_mul_f32 v[208:209], v[208:209], v[32:33]
    v_pk_mul_f32 v[210:211], v[210:211], v[34:35]
    v_exp_f32 v204, v204
    v_exp_f32 v206, v206
    v_exp_f32 v208, v208
    v_exp_f32 v210, v210
    v_exp_f32 v205, v205
    v_exp_f32 v207, v207
    v_exp_f32 v209, v209
    v_exp_f32 v211, v211
    v_pk_add_f32 v[204:205], v[204:205], v[216:217] op_sel_hi:[1,0]
    v_pk_add_f32 v[206:207], v[206:207], v[216:217] op_sel_hi:[1,0]
    v_pk_add_f32 v[208:209], v[208:209], v[216:217] op_sel_hi:[1,0]
    v_pk_add_f32 v[210:211], v[210:211], v[216:217] op_sel_hi:[1,0]
    v_rcp_f32 v204, v204
    v_rcp_f32 v206, v206
    v_rcp_f32 v208, v208
    v_rcp_f32 v210, v210
    v_rcp_f32 v205, v205
    v_rcp_f32 v207, v207
    v_rcp_f32 v209, v209
    v_rcp_f32 v211, v211
    v_pk_mul_f32 v[28:29], v[28:29], v[204:205]
    v_pk_mul_f32 v[30:31], v[30:31], v[206:207]
    v_pk_mul_f32 v[32:33], v[32:33], v[208:209]
    v_pk_mul_f32 v[34:35], v[34:35], v[210:211]
    s_add_u32 s64, s64, 0x10000
    v_cvt_pk_bf16_f32 v200, v28, v29
    v_cvt_pk_bf16_f32 v201, v30, v31
    v_cvt_pk_bf16_f32 v202, v32, v33
    v_cvt_pk_bf16_f32 v203, v34, v35
    buffer_store_dwordx4 v[200:203], v192, s[12:15], s64 offen sc1
L_g1_kernel_fin:
L_g1_kernel_end:
    s_endpgm

.section .rodata,"a"
.p2align 6
.amdhsa_kernel g1_kernel
  .amdhsa_next_free_vgpr 220
  .amdhsa_next_free_sgpr 96
  .amdhsa_accum_offset 220
  .amdhsa_group_segment_fixed_size 0
  .amdhsa_kernarg_size 96
  .amdhsa_user_sgpr_count 2
  .amdhsa_user_sgpr_kernarg_segment_ptr 1
  .amdhsa_system_sgpr_workgroup_id_x 1
.end_amdhsa_kernel

.text
.globl mid_kernel
.p2align 8
.type mid_kernel,@function
mid_kernel:
    s_cmp_ge_u32 s2, 512
    s_cbranch_scc1 L_mid_kernel_end
    s_load_dwordx16 s[40:55], s[0:1], 0
    s_load_dwordx8 s[56:63], s[0:1], 64
    v_and_b32 v1, 63, v0
    v_lshrrev_b32 v2, 6, v0
    s_nop 0
    v_readfirstlane_b32 s34, v2
    s_and_b32 s35, s2, 7
    s_lshr_b32 s36, s2, 3
    s_lshr_b32 s33, s36, 5
    s_xor_b32 s33, s33, s36
    s_and_b32 s33, s33, 1
    s_lshr_b32 s36, s36, 1
    s_cmp_eq_u32 s33, 0
    s_cbranch_scc1 L_mid_attn
    s_setprio 2
    v_and_b32 v3, 3, v2
    s_and_b32 s82, s34, 3
    s_lshl_b32 s37, s35, 2
    s_and_b32 s38, s36, 3
    s_add_u32 s70, s37, s38
    s_lshr_b32 s71, s36, 2
    s_lshl_b32 s32, s70, 6
    s_lshl_b32 s33, s71, 6
    s_lshl_b32 s37, s38, 1
    s_add_u32 s79, s37, s71
    s_and_b32 s79, s79, 7
    s_waitcnt lgkmcnt(0)
    s_add_u32 s4, s62, 0x600000
    s_addc_u32 s5, s63, 0
    s_mov_b32 s6, 0x200000
    s_mov_b32 s7, 0x20000
    s_mov_b32 s8, s50
    s_mov_b32 s9, s51
    s_mov_b32 s10, 0x80000
    s_mov_b32 s11, 0x20000
    s_add_u32 s12, s62, 0x800000
    s_addc_u32 s13, s63, 0
    s_mov_b32 s14, 0x200000
    s_mov_b32 s15, 0x20000
    s_mov_b32 s16, s40
    s_mov_b32 s17, s41
    s_mov_b32 s18, 0x200000
    s_mov_b32 s19, 0x20000
    s_add_u32 s20, s62, 0x1310000
    s_addc_u32 s21, s63, 0
    s_mov_b32 s22, 0x40000
    s_mov_b32 s23, 0x20000
    s_add_u32 s24, s62, 0x1360000
    s_addc_u32 s25, s63, 0
    s_mov_b32 s26, 0x20000
    s_mov_b32 s27, 0x20000
    s_mov_b32 s64, s56
    s_mov_b32 s65, s57
    s_mov_b32 s66, 0x400
    s_mov_b32 s67, 0x20000
    s_add_u32 s72, s62, 0x13a0000
    s_addc_u32 s73, s63, 0
    s_mov_b32 s74, 0x1000
    s_mov_b32 s75, 0x20000
    s_cmp_ge_u32 s34, 4
    s_cbranch_scc1 L_mid_kernel_A_ld
    s_lshr_b32 s37, s34, 1
    s_and_b32 s38, s34, 1
    s_lshl_b32 s39, s37, 5
    s_add_u32 s39, s39, s32
    v_and_b32 v69, 31, v1
    v_add_u32 v69, s39, v69
    v_lshlrev_b32 v68, 10, v69
    s_lshl_b32 s81, s39, 5
    s_lshl_b32 s39, s38, 5
    s_add_u32 s39, s39, s33
    s_lshl_b32 s80, s39, 12
    s_add_u32 s80, s80, s81
    s_add_u32 s81, s80, 0x10000
    s_lshl_b32 s39, s39, 1
    v_add_u32 v68, s39, v68
    v_lshrrev_b32 v71, 5, v1
    v_lshl_add_u32 v70, v71, 3, v68
    v_lshlrev_b32 v68, 4, v1
    v_lshlrev_b32 v72, 3, v71
    buffer_load_dwordx2 v[80:81], v70, s[16:19], 0 offen offset:0
    buffer_load_dwordx2 v[82:83], v70, s[16:19], 0 offen offset:16
    buffer_load_dwordx2 v[84:85], v70, s[16:19], 0 offen offset:32
    buffer_load_dwordx2 v[86:87], v70, s[16:19], 0 offen offset:48
    buffer_load_dwordx2 v[88:89], v72, s[64:67], s39 offen offset:0
    buffer_load_dwordx2 v[90:91], v72, s[64:67], s39 offen offset:16
    buffer_load_dwordx2 v[92:93], v72, s[64:67], s39 offen offset:32
    buffer_load_dwordx2 v[94:95], v72, s[64:67], s39 offen offset:48
    v_lshrrev_b32 v58, 1, v2
    v_and_b32 v59, 1, v2
    v_and_b32 v60, 31, v1
    v_lshrrev_b32 v61, 5, v1
    v_mul_u32_u24 v62, 1024, v58
    v_lshl_add_u32 v56, v1, 4, v62
    v_bfe_u32 v60, v1, 2, 2
    v_lshl_add_u32 v62, v61, 2, v60
    v_mul_u32_u24 v62, 128, v62
    v_and_b32 v63, 1, v1
    v_lshl_add_u32 v62, v63, 3, v62
    v_lshrrev_b32 v60, 1, v60
    v_lshlrev_b32 v60, 2, v60
    v_bfe_u32 v63, v1, 4, 1
    v_lshlrev_b32 v63, 1, v63
    v_bfe_u32 v61, v1, 1, 1
    v_add_u32 v63, v63, v61
    v_mul_u32_u24 v61, 4, v59
    v_add_u32 v63, v63, v61
    v_add_u32 v57, 0, v63
    v_xor_b32 v57, v57, v60
    v_lshl_add_u32 v57, v57, 4, v62
    s_lshl_b32 s83, s70, 1
    s_add_u32 s83, s83, s37
    s_barrier
    ds_read_b128 v[20:23], v56 offset:0
    ds_read_b64_tr_b16 v[36:37], v57 offset:8192
    ds_read_b64_tr_b16 v[38:39], v57 offset:9216
    ds_read_b128 v[24:27], v56 offset:2048
    ds_read_b64_tr_b16 v[40:41], v57 offset:10240
    ds_read_b64_tr_b16 v[42:43], v57 offset:11264
    ds_read_b128 v[28:31], v56 offset:4096
    ds_read_b64_tr_b16 v[44:45], v57 offset:12288
    ds_read_b64_tr_b16 v[46:47], v57 offset:13312
    s_waitcnt lgkmcnt(6)
    v_mfma_f32_32x32x16_bf16 v[4:19], v[36:39], v[20:23], 0
    ds_read_b128 v[32:35], v56 offset:6144
    ds_read_b64_tr_b16 v[48:49], v57 offset:14336
    ds_read_b64_tr_b16 v[50:51], v57 offset:15360
    s_waitcnt lgkmcnt(0)
    s_barrier
    v_mfma_f32_32x32x16_bf16 v[4:19], v[40:43], v[24:27], v[4:19]
    ds_read_b128 v[20:23], v56 offset:16384
    ds_read_b64_tr_b16 v[36:37], v57 offset:24576
    ds_read_b64_tr_b16 v[38:39], v57 offset:25600
    s_waitcnt lgkmcnt(6)
    v_mfma_f32_32x32x16_bf16 v[4:19], v[44:47], v[28:31], v[4:19]
    ds_read_b128 v[24:27], v56 offset:18432
    ds_read_b64_tr_b16 v[40:41], v57 offset:26624
    ds_read_b64_tr_b16 v[42:43], v57 offset:27648
    s_waitcnt lgkmcnt(6)
    v_mfma_f32_32x32x16_bf16 v[4:19], v[48:51], v[32:35], v[4:19]
    ds_read_b128 v[28:31], v56 offset:20480
    ds_read_b64_tr_b16 v[44:45], v57 offset:28672
    ds_read_b64_tr_b16 v[46:47], v57 offset:29696
    s_waitcnt lgkmcnt(6)
    v_mfma_f32_32x32x16_bf16 v[4:19], v[36:39], v[20:23], v[4:19]
    ds_read_b128 v[32:35], v56 offset:22528
    ds_read_b64_tr_b16 v[48:49], v57 offset:30720
    ds_read_b64_tr_b16 v[50:51], v57 offset:31744
    s_waitcnt lgkmcnt(0)
    s_barrier
    v_mfma_f32_32x32x16_bf16 v[4:19], v[40:43], v[24:27], v[4:19]
    ds_read_b128 v[20:23], v56 offset:32768
    ds_read_b64_tr_b16 v[36:37], v57 offset:40960
    ds_read_b64_tr_b16 v[38:39], v57 offset:41984
    s_waitcnt lgkmcnt(6)
    v_mfma_f32_32x32x16_bf16 v[4:19], v[44:47], v[28:31], v[4:19]
    ds_read_b128 v[24:27], v56 offset:34816
    ds_read_b64_tr_b16 v[40:41], v57 offset:43008
    ds_read_b64_tr_b16 v[42:43], v57 offset:44032
    s_waitcnt lgkmcnt(6)
    v_mfma_f32_32x32x16_bf16 v[4:19], v[48:51], v[32:35], v[4:19]
    ds_read_b128 v[28:31], v56 offset:36864
    ds_read_b64_tr_b16 v[44:45], v57 offset:45056
    ds_read_b64_tr_b16 v[46:47], v57 offset:46080
    s_waitcnt lgkmcnt(6)
    v_mfma_f32_32x32x16_bf16 v[4:19], v[36:39], v[20:23], v[4:19]
    ds_read_b128 v[32:35], v56 offset:38912
    ds_read_b64_tr_b16 v[48:49], v57 offset:47104
    ds_read_b64_tr_b16 v[50:51], v57 offset:48128
    s_waitcnt lgkmcnt(0)
    s_barrier
    v_mfma_f32_32x32x16_bf16 v[4:19], v[40:43], v[24:27], v[4:19]
    ds_read_b128 v[20:23], v56 offset:49152
    ds_read_b64_tr_b16 v[36:37], v57 offset:57344
    ds_read_b64_tr_b16 v[38:39], v57 offset:58368
    s_waitcnt lgkmcnt(6)
    v_mfma_f32_32x32x16_bf16 v[4:19], v[44:47], v[28:31], v[4:19]
    ds_read_b128 v[24:27], v56 offset:51200
    ds_read_b64_tr_b16 v[40:41], v57 offset:59392
    ds_read_b64_tr_b16 v[42:43], v57 offset:60416
    s_waitcnt lgkmcnt(6)
    v_mfma_f32_32x32x16_bf16 v[4:19], v[48:51], v[32:35], v[4:19]
    ds_read_b128 v[28:31], v56 offset:53248
    ds_read_b64_tr_b16 v[44:45], v57 offset:61440
    ds_read_b64_tr_b16 v[46:47], v57 offset:62464
    s_waitcnt lgkmcnt(6)
    v_mfma_f32_32x32x16_bf16 v[4:19], v[36:39], v[20:23], v[4:19]
    ds_read_b128 v[32:35], v56 offset:55296
    ds_read_b64_tr_b16 v[48:49], v57 offset:63488
    ds_read_b64_tr_b16 v[50:51], v57 offset:64512
    s_waitcnt lgkmcnt(0)
    s_barrier
    v_mfma_f32_32x32x16_bf16 v[4:19], v[40:43], v[24:27], v[4:19]
    ds_read_b128 v[20:23], v56 offset:0
    ds_read_b64_tr_b16 v[36:37], v57 offset:8192
    ds_read_b64_tr_b16 v[38:39], v57 offset:9216
    s_waitcnt lgkmcnt(6)
    v_mfma_f32_32x32x16_bf16 v[4:19], v[44:47], v[28:31], v[4:19]
    ds_read_b128 v[24:27], v56 offset:2048
    ds_read_b64_tr_b16 v[40:41], v57 offset:10240
    ds_read_b64_tr_b16 v[42:43], v57 offset:11264
    s_waitcnt lgkmcnt(6)
    v_mfma_f32_32x32x16_bf16 v[4:19], v[48:51], v[32:35], v[4:19]
    ds_read_b128 v[28:31], v56 offset:4096
    ds_read_b64_tr_b16 v[44:45], v57 offset:12288
    ds_read_b64_tr_b16 v[46:47], v57 offset:13312
    s_waitcnt lgkmcnt(6)
    v_mfma_f32_32x32x16_bf16 v[4:19], v[36:39], v[20:23], v[4:19]
    ds_read_b128 v[32:35], v56 offset:6144
    ds_read_b64_tr_b16 v[48:49], v57 offset:14336
    ds_read_b64_tr_b16 v[50:51], v57 offset:15360
    s_waitcnt lgkmcnt(0)
    s_barrier
    v_mfma_f32_32x32x16_bf16 v[4:19], v[40:43], v[24:27], v[4:19]
    ds_read_b128 v[20:23], v56 offset:16384
    ds_read_b64_tr_b16 v[36:37], v57 offset:24576
    ds_read_b64_tr_b16 v[38:39], v57 offset:25600
    s_waitcnt lgkmcnt(6)
    v_mfma_f32_32x32x16_bf16 v[4:19], v[44:47], v[28:31], v[4:19]
    ds_read_b128 v[24:27], v56 offset:18432
    ds_read_b64_tr_b16 v[40:41], v57 offset:26624
    ds_read_b64_tr_b16 v[42:43], v57 offset:27648
    s_waitcnt lgkmcnt(6)
    v_mfma_f32_32x32x16_bf16 v[4:19], v[48:51], v[32:35], v[4:19]
    ds_read_b128 v[28:31], v56 offset:20480
    ds_read_b64_tr_b16 v[44:45], v57 offset:28672
    ds_read_b64_tr_b16 v[46:47], v57 offset:29696
    s_waitcnt lgkmcnt(6)
    v_mfma_f32_32x32x16_bf16 v[4:19], v[36:39], v[20:23], v[4:19]
    ds_read_b128 v[32:35], v56 offset:22528
    ds_read_b64_tr_b16 v[48:49], v57 offset:30720
    ds_read_b64_tr_b16 v[50:51], v57 offset:31744
    s_waitcnt lgkmcnt(0)
    s_barrier
    v_mfma_f32_32x32x16_bf16 v[4:19], v[40:43], v[24:27], v[4:19]
    ds_read_b128 v[20:23], v56 offset:32768
    ds_read_b64_tr_b16 v[36:37], v57 offset:40960
    ds_read_b64_tr_b16 v[38:39], v57 offset:41984
    s_waitcnt lgkmcnt(6)
    v_mfma_f32_32x32x16_bf16 v[4:19], v[44:47], v[28:31], v[4:19]
    ds_read_b128 v[24:27], v56 offset:34816
    ds_read_b64_tr_b16 v[40:41], v57 offset:43008
    ds_read_b64_tr_b16 v[42:43], v57 offset:44032
    s_waitcnt lgkmcnt(6)
    v_mfma_f32_32x32x16_bf16 v[4:19], v[48:51], v[32:35], v[4:19]
    ds_read_b128 v[28:31], v56 offset:36864
    ds_read_b64_tr_b16 v[44:45], v57 offset:45056
    ds_read_b64_tr_b16 v[46:47], v57 offset:46080
    s_waitcnt lgkmcnt(6)
    v_mfma_f32_32x32x16_bf16 v[4:19], v[36:39], v[20:23], v[4:19]
    ds_read_b128 v[32:35], v56 offset:38912
    ds_read_b64_tr_b16 v[48:49], v57 offset:47104
    ds_read_b64_tr_b16 v[50:51], v57 offset:48128
    s_waitcnt lgkmcnt(0)
    s_barrier
    v_mfma_f32_32x32x16_bf16 v[4:19], v[40:43], v[24:27], v[4:19]
    ds_read_b128 v[20:23], v56 offset:49152
    ds_read_b64_tr_b16 v[36:37], v57 offset:57344
    ds_read_b64_tr_b16 v[38:39], v57 offset:58368
    s_waitcnt lgkmcnt(6)
    v_mfma_f32_32x32x16_bf16 v[4:19], v[44:47], v[28:31], v[4:19]
    ds_read_b128 v[24:27], v56 offset:51200
    ds_read_b64_tr_b16 v[40:41], v57 offset:59392
    ds_read_b64_tr_b16 v[42:43], v57 offset:60416
    s_waitcnt lgkmcnt(6)
    v_mfma_f32_32x32x16_bf16 v[4:19], v[48:51], v[32:35], v[4:19]
    ds_read_b128 v[28:31], v56 offset:53248
    ds_read_b64_tr_b16 v[44:45], v57 offset:61440
    ds_read_b64_tr_b16 v[46:47], v57 offset:62464
    s_waitcnt lgkmcnt(6)
    v_mfma_f32_32x32x16_bf16 v[4:19], v[36:39], v[20:23], v[4:19]
    ds_read_b128 v[32:35], v56 offset:55296
    ds_read_b64_tr_b16 v[48:49], v57 offset:63488
    ds_read_b64_tr_b16 v[50:51], v57 offset:64512
    s_waitcnt lgkmcnt(6)
    v_mfma_f32_32x32x16_bf16 v[4:19], v[40:43], v[24:27], v[4:19]
    s_waitcnt lgkmcnt(3)
    v_mfma_f32_32x32x16_bf16 v[4:19], v[44:47], v[28:31], v[4:19]
    s_waitcnt lgkmcnt(0)
    v_mfma_f32_32x32x16_bf16 v[4:19], v[48:51], v[32:35], v[4:19]
    s_waitcnt vmcnt(0)
    s_nop 7
    v_mov_b32 v73, 0
    v_mov_b32 v74, 0
    v_mov_b32 v75, 0
    v_mov_b32 v76, 0
    v_lshlrev_b32 v70, 16, v80
    v_and_b32 v71, 0xffff0000, v80
    v_lshlrev_b32 v72, 16, v88
    v_fmac_f32 v75, v70, v72
    v_and_b32 v72, 0xffff0000, v88
    v_add_f32 v4, v4, v70
    v_add_f32 v5, v5, v71
    v_fmac_f32 v76, v71, v72
    v_add_f32 v73, v73, v4
    v_fmac_f32 v74, v4, v4
    v_add_f32 v73, v73, v5
    v_fmac_f32 v74, v5, v5
    v_lshlrev_b32 v70, 16, v81
    v_and_b32 v71, 0xffff0000, v81
    v_lshlrev_b32 v72, 16, v89
    v_fmac_f32 v75, v70, v72
    v_and_b32 v72, 0xffff0000, v89
    v_add_f32 v6, v6, v70
    v_add_f32 v7, v7, v71
    v_fmac_f32 v76, v71, v72
    v_add_f32 v73, v73, v6
    v_fmac_f32 v74, v6, v6
    v_add_f32 v73, v73, v7
    v_fmac_f32 v74, v7, v7
    v_lshlrev_b32 v70, 16, v82
    v_and_b32 v71, 0xffff0000, v82
    v_lshlrev_b32 v72, 16, v90
    v_fmac_f32 v75, v70, v72
    v_and_b32 v72, 0xffff0000, v90
    v_add_f32 v8, v8, v70
    v_add_f32 v9, v9, v71
    v_fmac_f32 v76, v71, v72
    v_add_f32 v73, v73, v8
    v_fmac_f32 v74, v8, v8
    v_add_f32 v73, v73, v9
    v_fmac_f32 v74, v9, v9
    v_lshlrev_b32 v70, 16, v83
    v_and_b32 v71, 0xffff0000, v83
    v_lshlrev_b32 v72, 16, v91
    v_fmac_f32 v75, v70, v72
    v_and_b32 v72, 0xffff0000, v91
    v_add_f32 v10, v10, v70
    v_add_f32 v11, v11, v71
    v_fmac_f32 v76, v71, v72
    v_add_f32 v73, v73, v10
    v_fmac_f32 v74, v10, v10
    v_add_f32 v73, v73, v11
    v_fmac_f32 v74, v11, v11
    v_lshlrev_b32 v70, 16, v84
    v_and_b32 v71, 0xffff0000, v84
    v_lshlrev_b32 v72, 16, v92
    v_fmac_f32 v75, v70, v72
    v_and_b32 v72, 0xffff0000, v92
    v_add_f32 v12, v12, v70
    v_add_f32 v13, v13, v71
    v_fmac_f32 v76, v71, v72
    v_add_f32 v73, v73, v12
    v_fmac_f32 v74, v12, v12
    v_add_f32 v73, v73, v13
    v_fmac_f32 v74, v13, v13
    v_lshlrev_b32 v70, 16, v85
    v_and_b32 v71, 0xffff0000, v85
    v_lshlrev_b32 v72, 16, v93
    v_fmac_f32 v75, v70, v72
    v_and_b32 v72, 0xffff0000, v93
    v_add_f32 v14, v14, v70
    v_add_f32 v15, v15, v71
    v_fmac_f32 v76, v71, v72
    v_add_f32 v73, v73, v14
    v_fmac_f32 v74, v14, v14
    v_add_f32 v73, v73, v15
    v_fmac_f32 v74, v15, v15
    v_lshlrev_b32 v70, 16, v86
    v_and_b32 v71, 0xffff0000, v86
    v_lshlrev_b32 v72, 16, v94
    v_fmac_f32 v75, v70, v72
    v_and_b32 v72, 0xffff0000, v94
    v_add_f32 v16, v16, v70
    v_add_f32 v17, v17, v71
    v_fmac_f32 v76, v71, v72
    v_add_f32 v73, v73, v16
    v_fmac_f32 v74, v16, v16
    v_add_f32 v73, v73, v17
    v_fmac_f32 v74, v17, v17
    v_lshlrev_b32 v70, 16, v87
    v_and_b32 v71, 0xffff0000, v87
    v_lshlrev_b32 v72, 16, v95
    v_fmac_f32 v75, v70, v72
    v_and_b32 v72, 0xffff0000, v95
    v_add_f32 v18, v18, v70
    v_add_f32 v19, v19, v71
    v_fmac_f32 v76, v71, v72
    v_add_f32 v73, v73, v18
    v_fmac_f32 v74, v18, v18
    v_add_f32 v73, v73, v19
    v_fmac_f32 v74, v19, v19
    v_cvt_pk_bf16_f32 v96, v4, v5
    v_cvt_pk_bf16_f32 v97, v6, v7
    v_cvt_pk_bf16_f32 v98, v8, v9
    v_cvt_pk_bf16_f32 v99, v10, v11
    buffer_store_dwordx4 v[96:99], v68, s[12:15], s80 offen sc1
    v_cvt_pk_bf16_f32 v100, v12, v13
    v_cvt_pk_bf16_f32 v101, v14, v15
    v_cvt_pk_bf16_f32 v102, v16, v17
    v_cvt_pk_bf16_f32 v103, v18, v19
    buffer_store_dwordx4 v[100:103], v68, s[12:15], s81 offen sc1
    v_add_f32 v75, v75, v76
    v_lshrrev_b32 v71, 5, v1
    v_mov_b32 v76, v75
    v_and_b32 v70, 31, v1
    v_lshlrev_b32 v72, 4, v70
    v_lshl_add_u32 v70, v71, 2, v72
    v_permlane32_swap_b32 v73, v74
    v_permlane32_swap_b32 v75, v76
    s_lshl_b32 s64, s83, 3
    s_add_u32 s64, s64, s71
    s_lshl_b32 s64, s64, 9
    s_lshl_b32 s65, s38, 3
    s_add_u32 s64, s64, s65
    s_lshl_b32 s65, s83, 2
    s_lshr_b32 s66, s71, 1
    s_add_u32 s65, s65, s66
    s_lshl_b32 s65, s65, 9
    s_and_b32 s66, s71, 1
    s_lshl_b32 s66, s66, 1
    s_add_u32 s66, s66, s38
    s_lshl_b32 s66, s66, 2
    s_add_u32 s65, s65, s66
    v_add_f32 v73, v73, v74
    v_add_f32 v75, v75, v76
    buffer_store_dword v73, v70, s[20:23], s64 offen sc1
    buffer_store_dword v75, v72, s[24:27], s65 offen sc1
    s_waitcnt vmcnt(0)
    s_branch L_mid_kernel_A_join
L_mid_kernel_A_ld:
    s_mul_i32 s28, s82, 2048
    s_mul_i32 s29, s82, 2048
    s_add_u32 s29, s29, 8192
    v_mul_u32_u24 v58, 2, v3
    v_and_b32 v59, 1, v58
    v_lshrrev_b32 v58, 1, v58
    v_and_b32 v60, 31, v1
    v_lshl_add_u32 v60, v59, 5, v60
    v_add_u32 v52, s32, v60
    v_lshrrev_b32 v60, 5, v1
    v_lshlrev_b32 v60, 9, v60
    v_lshl_add_u32 v66, v58, 16, v60
    v_mul_u32_u24 v58, 2, v3
    v_add_u32 v58, 1, v58
    v_and_b32 v59, 1, v58
    v_lshrrev_b32 v58, 1, v58
    v_and_b32 v60, 31, v1
    v_lshl_add_u32 v60, v59, 5, v60
    v_add_u32 v53, s32, v60
    v_lshrrev_b32 v60, 5, v1
    v_lshlrev_b32 v60, 9, v60
    v_lshl_add_u32 v67, v58, 16, v60
    v_lshrrev_b32 v58, 3, v1
    v_mul_u32_u24 v59, 16, v3
    v_add_u32 v58, v58, v59
    v_and_b32 v60, 7, v1
    v_lshrrev_b32 v59, 4, v1
    v_and_b32 v59, 1, v59
    v_lshlrev_b32 v59, 2, v59
    v_xor_b32 v60, v60, v59
    v_lshlrev_b32 v60, 4, v60
    s_lshl_b32 s30, s33, 1
    v_add_u32 v60, s30, v60
    s_mov_b32 s30, 1024
    v_mul_lo_u32 v63, v58, s30
    v_add_u32 v54, v63, v60
    v_add_u32 v55, v63, v60
    v_add_u32 v55, 0x2000, v55
    v_subrev_u32 v55, 1024, v55
    s_setprio 2
    s_mul_i32 s30, s79, 0x40000
    s_lshr_b32 s78, s30, 20
    s_add_u32 s78, s78, 1
    s_sub_u32 s76, 0, s78
    s_bitcmp1_b32 s30, 19
    s_cselect_b32 s78, s78, s76
    s_movk_i32 s76, 2048
    v_add_u32 v58, s78, v52
    v_lshrrev_b32 v59, 5, v58
    v_and_b32 v64, 31, v58
    v_cmp_gt_u32 vcc, s76, v58
    v_lshl_add_u32 v64, v64, 4, v66
    v_lshl_add_u32 v64, v59, 10, v64
    v_bfrev_b32 v59, 1
    v_cndmask_b32 v64, v59, v64, vcc
    v_add_u32 v58, s78, v53
    v_lshrrev_b32 v59, 5, v58
    v_and_b32 v65, 31, v58
    v_cmp_gt_u32 vcc, s76, v58
    v_lshl_add_u32 v65, v65, 4, v67
    v_lshl_add_u32 v65, v59, 10, v65
    v_bfrev_b32 v59, 1
    v_cndmask_b32 v65, v59, v65, vcc
    s_add_u32 m0, s28, 0x0
    s_nop 0
    buffer_load_dwordx4 v64, s[4:7], s30 offen offset:0 lds
    s_add_u32 m0, s28, 0x400
    s_nop 0
    buffer_load_dwordx4 v65, s[4:7], s30 offen offset:0 lds
    s_mul_i32 s31, s79, 0x10000
    s_add_u32 m0, s29, 0x0
    s_nop 0
    buffer_load_dwordx4 v54, s[8:11], s31 offen offset:0 lds
    buffer_load_dwordx4 v55, s[8:11], s31 offen offset:1024 lds
    s_add_u32 s30, s30, 0x40000
    s_cmp_eq_u32 s30, 0x200000
    s_cselect_b32 s30, 0x0, s30
    s_lshr_b32 s78, s30, 20
    s_add_u32 s78, s78, 1
    s_sub_u32 s76, 0, s78
    s_bitcmp1_b32 s30, 19
    s_cselect_b32 s78, s78, s76
    s_movk_i32 s76, 2048
    v_add_u32 v58, s78, v52
    v_lshrrev_b32 v59, 5, v58
    v_and_b32 v64, 31, v58
    v_cmp_gt_u32 vcc, s76, v58
    v_lshl_add_u32 v64, v64, 4, v66
    v_lshl_add_u32 v64, v59, 10, v64
    v_bfrev_b32 v59, 1
    v_cndmask_b32 v64, v59, v64, vcc
    v_add_u32 v58, s78, v53
    v_lshrrev_b32 v59, 5, v58
    v_and_b32 v65, 31, v58
    v_cmp_gt_u32 vcc, s76, v58
    v_lshl_add_u32 v65, v65, 4, v67
    v_lshl_add_u32 v65, v59, 10, v65
    v_bfrev_b32 v59, 1
    v_cndmask_b32 v65, v59, v65, vcc
    s_add_u32 m0, s28, 0x4000
    s_nop 0
    buffer_load_dwordx4 v64, s[4:7], s30 offen offset:0 lds
    s_add_u32 m0, s28, 0x4400
    s_nop 0
    buffer_load_dwordx4 v65, s[4:7], s30 offen offset:0 lds
    s_add_u32 s31, s31, 0x10000
    s_cmp_eq_u32 s31, 0x80000
    s_cselect_b32 s31, 0x0, s31
    s_add_u32 m0, s29, 0x4000
    s_nop 0
    buffer_load_dwordx4 v54, s[8:11], s31 offen offset:0 lds
    buffer_load_dwordx4 v55, s[8:11], s31 offen offset:1024 lds
    s_add_u32 s30, s30, 0x40000
    s_cmp_eq_u32 s30, 0x200000
    s_cselect_b32 s30, 0x0, s30
    s_lshr_b32 s78, s30, 20
    s_add_u32 s78, s78, 1
    s_sub_u32 s76, 0, s78
    s_bitcmp1_b32 s30, 19
    s_cselect_b32 s78, s78, s76
    s_movk_i32 s76, 2048
    v_add_u32 v58, s78, v52
    v_lshrrev_b32 v59, 5, v58
    v_and_b32 v64, 31, v58
    v_cmp_gt_u32 vcc, s76, v58
    v_lshl_add_u32 v64, v64, 4, v66
    v_lshl_add_u32 v64, v59, 10, v64
    v_bfrev_b32 v59, 1
    v_cndmask_b32 v64, v59, v64, vcc
    v_add_u32 v58, s78, v53
    v_lshrrev_b32 v59, 5, v58
    v_and_b32 v65, 31, v58
    v_cmp_gt_u32 vcc, s76, v58
    v_lshl_add_u32 v65, v65, 4, v67
    v_lshl_add_u32 v65, v59, 10, v65
    v_bfrev_b32 v59, 1
    v_cndmask_b32 v65, v59, v65, vcc
    s_add_u32 m0, s28, 0x8000
    s_nop 0
    buffer_load_dwordx4 v64, s[4:7], s30 offen offset:0 lds
    s_add_u32 m0, s28, 0x8400
    s_nop 0
    buffer_load_dwordx4 v65, s[4:7], s30 offen offset:0 lds
    s_add_u32 s31, s31, 0x10000
    s_cmp_eq_u32 s31, 0x80000
    s_cselect_b32 s31, 0x0, s31
    s_add_u32 m0, s29, 0x8000
    s_nop 0
    buffer_load_dwordx4 v54, s[8:11], s31 offen offset:0 lds
    buffer_load_dwordx4 v55, s[8:11], s31 offen offset:1024 lds
    s_add_u32 s30, s30, 0x40000
    s_cmp_eq_u32 s30, 0x200000
    s_cselect_b32 s30, 0x0, s30
    s_lshr_b32 s78, s30, 20
    s_add_u32 s78, s78, 1
    s_sub_u32 s76, 0, s78
    s_bitcmp1_b32 s30, 19
    s_cselect_b32 s78, s78, s76
    s_movk_i32 s76, 2048
    v_add_u32 v58, s78, v52
    v_lshrrev_b32 v59, 5, v58
    v_and_b32 v64, 31, v58
    v_cmp_gt_u32 vcc, s76, v58
    v_lshl_add_u32 v64, v64, 4, v66
    v_lshl_add_u32 v64, v59, 10, v64
    v_bfrev_b32 v59, 1
    v_cndmask_b32 v64, v59, v64, vcc
    v_add_u32 v58, s78, v53
    v_lshrrev_b32 v59, 5, v58
    v_and_b32 v65, 31, v58
    v_cmp_gt_u32 vcc, s76, v58
    v_lshl_add_u32 v65, v65, 4, v67
    v_lshl_add_u32 v65, v59, 10, v65
    v_bfrev_b32 v59, 1
    v_cndmask_b32 v65, v59, v65, vcc
    s_add_u32 m0, s28, 0xc000
    s_nop 0
    buffer_load_dwordx4 v64, s[4:7], s30 offen offset:0 lds
    s_add_u32 m0, s28, 0xc400
    s_nop 0
    buffer_load_dwordx4 v65, s[4:7], s30 offen offset:0 lds
    s_add_u32 s31, s31, 0x10000
    s_cmp_eq_u32 s31, 0x80000
    s_cselect_b32 s31, 0x0, s31
    s_add_u32 m0, s29, 0xc000
    s_nop 0
    buffer_load_dwordx4 v54, s[8:11], s31 offen offset:0 lds
    buffer_load_dwordx4 v55, s[8:11], s31 offen offset:1024 lds
    s_waitcnt vmcnt(12)
    s_barrier
    s_waitcnt vmcnt(8)
    s_barrier
    s_add_u32 s30, s30, 0x40000
    s_cmp_eq_u32 s30, 0x200000
    s_cselect_b32 s30, 0x0, s30
    s_lshr_b32 s78, s30, 20
    s_add_u32 s78, s78, 1
    s_sub_u32 s76, 0, s78
    s_bitcmp1_b32 s30, 19
    s_cselect_b32 s78, s78, s76
    s_movk_i32 s76, 2048
    v_add_u32 v58, s78, v52
    v_lshrrev_b32 v59, 5, v58
    v_and_b32 v64, 31, v58
    v_cmp_gt_u32 vcc, s76, v58
    v_lshl_add_u32 v64, v64, 4, v66
    v_lshl_add_u32 v64, v59, 10, v64
    v_bfrev_b32 v59, 1
    v_cndmask_b32 v64, v59, v64, vcc
    v_add_u32 v58, s78, v53
    v_lshrrev_b32 v59, 5, v58
    v_and_b32 v65, 31, v58
    v_cmp_gt_u32 vcc, s76, v58
    v_lshl_add_u32 v65, v65, 4, v67
    v_lshl_add_u32 v65, v59, 10, v65
    v_bfrev_b32 v59, 1
    v_cndmask_b32 v65, v59, v65, vcc
    s_add_u32 m0, s28, 0x0
    s_nop 0
    buffer_load_dwordx4 v64, s[4:7], s30 offen offset:0 lds
    s_add_u32 m0, s28, 0x400
    s_nop 0
    buffer_load_dwordx4 v65, s[4:7], s30 offen offset:0 lds
    s_add_u32 s31, s31, 0x10000
    s_cmp_eq_u32 s31, 0x80000
    s_cselect_b32 s31, 0x0, s31
    s_add_u32 m0, s29, 0x0
    s_nop 0
    buffer_load_dwordx4 v54, s[8:11], s31 offen offset:0 lds
    buffer_load_dwordx4 v55, s[8:11], s31 offen offset:1024 lds
    s_waitcnt vmcnt(8)
    s_barrier
    s_add_u32 s30, s30, 0x40000
    s_cmp_eq_u32 s30, 0x200000
    s_cselect_b32 s30, 0x0, s30
    s_lshr_b32 s78, s30, 20
    s_add_u32 s78, s78, 1
    s_sub_u32 s76, 0, s78
    s_bitcmp1_b32 s30, 19
    s_cselect_b32 s78, s78, s76
    s_movk_i32 s76, 2048
    v_add_u32 v58, s78, v52
    v_lshrrev_b32 v59, 5, v58
    v_and_b32 v64, 31, v58
    v_cmp_gt_u32 vcc, s76, v58
    v_lshl_add_u32 v64, v64, 4, v66
    v_lshl_add_u32 v64, v59, 10, v64
    v_bfrev_b32 v59, 1
    v_cndmask_b32 v64, v59, v64, vcc
    v_add_u32 v58, s78, v53
    v_lshrrev_b32 v59, 5, v58
    v_and_b32 v65, 31, v58
    v_cmp_gt_u32 vcc, s76, v58
    v_lshl_add_u32 v65, v65, 4, v67
    v_lshl_add_u32 v65, v59, 10, v65
    v_bfrev_b32 v59, 1
    v_cndmask_b32 v65, v59, v65, vcc
    s_add_u32 m0, s28, 0x4000
    s_nop 0
    buffer_load_dwordx4 v64, s[4:7], s30 offen offset:0 lds
    s_add_u32 m0, s28, 0x4400
    s_nop 0
    buffer_load_dwordx4 v65, s[4:7], s30 offen offset:0 lds
    s_add_u32 s31, s31, 0x10000
    s_cmp_eq_u32 s31, 0x80000
    s_cselect_b32 s31, 0x0, s31
    s_add_u32 m0, s29, 0x4000
    s_nop 0
    buffer_load_dwordx4 v54, s[8:11], s31 offen offset:0 lds
    buffer_load_dwordx4 v55, s[8:11], s31 offen offset:1024 lds
    s_waitcnt vmcnt(8)
    s_barrier
    s_add_u32 s30, s30, 0x40000
    s_cmp_eq_u32 s30, 0x200000
    s_cselect_b32 s30, 0x0, s30
    s_lshr_b32 s78, s30, 20
    s_add_u32 s78, s78, 1
    s_sub_u32 s76, 0, s78
    s_bitcmp1_b32 s30, 19
    s_cselect_b32 s78, s78, s76
    s_movk_i32 s76, 2048
    v_add_u32 v58, s78, v52
    v_lshrrev_b32 v59, 5, v58
    v_and_b32 v64, 31, v58
    v_cmp_gt_u32 vcc, s76, v58
    v_lshl_add_u32 v64, v64, 4, v66
    v_lshl_add_u32 v64, v59, 10, v64
    v_bfrev_b32 v59, 1
    v_cndmask_b32 v64, v59, v64, vcc
    v_add_u32 v58, s78, v53
    v_lshrrev_b32 v59, 5, v58
    v_and_b32 v65, 31, v58
    v_cmp_gt_u32 vcc, s76, v58
    v_lshl_add_u32 v65, v65, 4, v67
    v_lshl_add_u32 v65, v59, 10, v65
    v_bfrev_b32 v59, 1
    v_cndmask_b32 v65, v59, v65, vcc
    s_add_u32 m0, s28, 0x8000
    s_nop 0
    buffer_load_dwordx4 v64, s[4:7], s30 offen offset:0 lds
    s_add_u32 m0, s28, 0x8400
    s_nop 0
    buffer_load_dwordx4 v65, s[4:7], s30 offen offset:0 lds
    s_add_u32 s31, s31, 0x10000
    s_cmp_eq_u32 s31, 0x80000
    s_cselect_b32 s31, 0x0, s31
    s_add_u32 m0, s29, 0x8000
    s_nop 0
    buffer_load_dwordx4 v54, s[8:11], s31 offen offset:0 lds
    buffer_load_dwordx4 v55, s[8:11], s31 offen offset:1024 lds
    s_waitcnt vmcnt(8)
    s_barrier
    s_add_u32 s30, s30, 0x40000
    s_cmp_eq_u32 s30, 0x200000
    s_cselect_b32 s30, 0x0, s30
    s_lshr_b32 s78, s30, 20
    s_add_u32 s78, s78, 1
    s_sub_u32 s76, 0, s78
    s_bitcmp1_b32 s30, 19
    s_cselect_b32 s78, s78, s76
    s_movk_i32 s76, 2048
    v_add_u32 v58, s78, v52
    v_lshrrev_b32 v59, 5, v58
    v_and_b32 v64, 31, v58
    v_cmp_gt_u32 vcc, s76, v58
    v_lshl_add_u32 v64, v64, 4, v66
    v_lshl_add_u32 v64, v59, 10, v64
    v_bfrev_b32 v59, 1
    v_cndmask_b32 v64, v59, v64, vcc
    v_add_u32 v58, s78, v53
    v_lshrrev_b32 v59, 5, v58
    v_and_b32 v65, 31, v58
    v_cmp_gt_u32 vcc, s76, v58
    v_lshl_add_u32 v65, v65, 4, v67
    v_lshl_add_u32 v65, v59, 10, v65
    v_bfrev_b32 v59, 1
    v_cndmask_b32 v65, v59, v65, vcc
    s_add_u32 m0, s28, 0xc000
    s_nop 0
    buffer_load_dwordx4 v64, s[4:7], s30 offen offset:0 lds
    s_add_u32 m0, s28, 0xc400
    s_nop 0
    buffer_load_dwordx4 v65, s[4:7], s30 offen offset:0 lds
    s_add_u32 s31, s31, 0x10000
    s_cmp_eq_u32 s31, 0x80000
    s_cselect_b32 s31, 0x0, s31
    s_add_u32 m0, s29, 0xc000
    s_nop 0
    buffer_load_dwordx4 v54, s[8:11], s31 offen offset:0 lds
    buffer_load_dwordx4 v55, s[8:11], s31 offen offset:1024 lds
    s_setprio 0
    s_mov_b32 s16, s52
    s_mov_b32 s17, s53
    s_mov_b32 s18, 0x1c0000
    s_mov_b32 s19, 0x20000
    s_lshl_b32 s64, s36, 2
    s_add_u32 s64, s64, s82
    s_mul_i32 s64, s64, 14336
    v_lshlrev_b32 v70, 4, v1
    s_mov_b32 m0, 65536
    s_nop 0
    buffer_load_dwordx4 v70, s[16:19], s64 offen lds
    s_add_u32 s64, s64, 1024
    buffer_load_dwordx4 v70, s[16:19], s64 offen lds
    s_add_u32 s64, s64, 1024
    buffer_load_dwordx4 v70, s[16:19], s64 offen lds
    s_add_u32 s64, s64, 1024
    buffer_load_dwordx4 v70, s[16:19], s64 offen lds
    s_add_u32 s64, s64, 1024
    buffer_load_dwordx4 v70, s[16:19], s64 offen lds
    s_add_u32 s64, s64, 1024
    buffer_load_dwordx4 v70, s[16:19], s64 offen lds
    s_add_u32 s64, s64, 1024
    buffer_load_dwordx4 v70, s[16:19], s64 offen lds
    s_add_u32 s64, s64, 1024
    buffer_load_dwordx4 v70, s[16:19], s64 offen lds
    s_add_u32 s64, s64, 1024
    buffer_load_dwordx4 v70, s[16:19], s64 offen lds
    s_add_u32 s64, s64, 1024
    buffer_load_dwordx4 v70, s[16:19], s64 offen lds
    s_add_u32 s64, s64, 1024
    buffer_load_dwordx4 v70, s[16:19], s64 offen lds
    s_add_u32 s64, s64, 1024
    buffer_load_dwordx4 v70, s[16:19], s64 offen lds
    s_add_u32 s64, s64, 1024
    buffer_load_dwordx4 v70, s[16:19], s64 offen lds
    s_add_u32 s64, s64, 1024
    buffer_load_dwordx4 v70, s[16:19], s64 offen lds
    s_waitcnt vmcnt(22)
    s_barrier
    s_waitcnt vmcnt(18)
    s_barrier
    s_waitcnt vmcnt(14)
    s_barrier
L_mid_kernel_A_join:
    s_lshr_b32 s64, s70, 1
    s_lshl_b32 s64, s64, 6
    s_and_b32 s65, s70, 1
    s_lshl_b32 s65, s65, 3
    s_add_u32 s65, s65, s71
    s_lshl_b32 s65, s65, 2
    s_add_u32 s64, s64, s65
    s_add_u32 s64, s64, 3072
    s_barrier
    s_cmp_lg_u32 s34, 0
    s_cbranch_scc1 L_mid_kernel_pub_1
    v_mov_b32 v70, 0
    v_mov_b32 v71, 1
    s_mov_b64 exec, 1
    buffer_store_dword v71, v70, s[72:75], s64 offen sc1
    s_mov_b64 exec, -1
L_mid_kernel_pub_1:
    s_setprio 0
    s_mov_b32 s24, s54
    s_mov_b32 s25, s55
    s_mov_b32 s26, 0x1c0000
    s_mov_b32 s27, 0x20000
    s_lshl_b32 s3, s36, 3
    s_add_u32 s3, s3, s34
    s_mul_i32 s3, s3, 7168
    v_lshlrev_b32 v3, 4, v1
    s_cmp_eq_u32 s34, 0
    s_cbranch_scc1 L_mid_kernel_pf4_2
    s_mov_b32 m0, 65536
    s_nop 0
    buffer_load_dwordx4 v3, s[24:27], s3 offen lds
    s_add_u32 s3, s3, 1024
    buffer_load_dwordx4 v3, s[24:27], s3 offen lds
    s_add_u32 s3, s3, 1024
    buffer_load_dwordx4 v3, s[24:27], s3 offen lds
    s_add_u32 s3, s3, 1024
    buffer_load_dwordx4 v3, s[24:27], s3 offen lds
    s_add_u32 s3, s3, 1024
    buffer_load_dwordx4 v3, s[24:27], s3 offen lds
    s_add_u32 s3, s3, 1024
    buffer_load_dwordx4 v3, s[24:27], s3 offen lds
    s_add_u32 s3, s3, 1024
    buffer_load_dwordx4 v3, s[24:27], s3 offen lds
    s_add_u32 s3, s3, 1024
    buffer_load_dwordx4 v3, s[24:27], s3 offen lds
L_mid_kernel_pf4_2:
    s_cmp_ge_u32 s36, 28
    s_cbranch_scc1 L_mid_kernel_B_skip
    s_lshl_b32 s37, s35, 1
    s_and_b32 s38, s36, 1
    s_add_u32 s70, s37, s38
    s_lshr_b32 s71, s36, 1
    s_lshl_b32 s32, s70, 7
    s_lshl_b32 s33, s71, 7
    s_lshl_b32 s37, s38, 2
    s_add_u32 s79, s37, s71
    s_and_b32 s79, s79, 7
    s_lshl_b32 s79, s79, 1
    s_add_u32 s4, s62, 0x800000
    s_addc_u32 s5, s63, 0
    s_mov_b32 s6, 0x200000
    s_mov_b32 s7, 0x20000
    s_mov_b32 s8, s52
    s_mov_b32 s9, s53
    s_mov_b32 s10, 0x1c0000
    s_mov_b32 s11, 0x20000
    s_add_u32 s12, s62, 0xc00000
    s_addc_u32 s13, s63, 0
    s_mov_b32 s14, 0x700000
    s_mov_b32 s15, 0x20000
    s_add_u32 s16, s62, 0x1310000
    s_addc_u32 s17, s63, 0
    s_mov_b32 s18, 0x40000
    s_mov_b32 s19, 0x20000
    s_add_u32 s20, s62, 0x1390000
    s_addc_u32 s21, s63, 0
    s_mov_b32 s22, 0x1c00
    s_mov_b32 s23, 0x20000
    s_mul_i32 s28, s34, 1024
    s_mul_i32 s29, s34, 1024
    s_add_u32 s29, s29, 8192
    v_mul_u32_u24 v65, 1, v2
    v_and_b32 v66, 3, v65
    v_lshrrev_b32 v65, 2, v65
    v_lshlrev_b32 v60, 4, v1
    v_lshl_add_u32 v60, v66, 10, v60
    v_lshl_add_u32 v60, v65, 16, v60
    s_lshl_b32 s30, s32, 5
    v_add_u32 v60, s30, v60
    v_lshrrev_b32 v65, 4, v1
    v_mul_u32_u24 v66, 4, v2
    v_add_u32 v65, v65, v66
    v_and_b32 v67, 15, v1
    v_lshrrev_b32 v66, 4, v1
    v_lshlrev_b32 v66, 2, v66
    v_xor_b32 v67, v67, v66
    v_lshlrev_b32 v67, 4, v67
    s_lshl_b32 s30, s33, 1
    v_add_u32 v67, s30, v67
    s_mov_b32 s30, 3584
    v_mul_lo_u32 v70, v65, s30
    v_add_u32 v61, v70, v67
    v_lshrrev_b32 v65, 1, v2
    v_and_b32 v66, 1, v2
    v_and_b32 v67, 31, v1
    v_lshrrev_b32 v68, 5, v1
    v_mul_u32_u24 v69, 1024, v65
    v_lshl_add_u32 v62, v1, 4, v69
    v_bfe_u32 v67, v1, 2, 2
    v_lshl_add_u32 v69, v68, 2, v67
    v_mul_u32_u24 v69, 256, v69
    v_and_b32 v70, 1, v1
    v_lshl_add_u32 v69, v70, 3, v69
    v_lshlrev_b32 v67, 2, v67
    v_bfe_u32 v70, v1, 4, 1
    v_lshlrev_b32 v70, 1, v70
    v_bfe_u32 v68, v1, 1, 1
    v_add_u32 v70, v70, v68
    v_mul_u32_u24 v68, 8, v66
    v_add_u32 v70, v70, v68
    v_add_u32 v63, 0, v70
    v_xor_b32 v63, v63, v67
    v_lshl_add_u32 v63, v63, 4, v69
    v_add_u32 v64, 4, v70
    v_xor_b32 v64, v64, v67
    v_lshl_add_u32 v64, v64, 4, v69
    s_lshr_b32 s37, s34, 1
    s_and_b32 s38, s34, 1
    s_lshl_b32 s39, s37, 5
    s_add_u32 s39, s39, s32
    v_and_b32 v65, 31, v1
    v_lshlrev_b32 v67, 4, v65
    v_add_u32 v65, s39, v65
    v_lshrrev_b32 v66, 5, v1
    v_lshl_add_u32 v67, v66, 11, v67
    s_lshr_b32 s80, s39, 5
    s_lshl_b32 s80, s80, 12
    s_lshl_b32 s64, s38, 6
    s_add_u32 s64, s64, s33
    s_lshl_b32 s81, s64, 2
    v_lshlrev_b32 v68, 4, v66
    v_lshlrev_b32 v124, 4, v1
    s_lshl_b32 s68, s64, 12
    s_add_u32 s69, s68, 0x20000
    s_lshl_b32 s83, s39, 5
    s_mul_i32 s31, s79, 0x1c000
    s_add_u32 m0, s29, 0x0
    s_setprio 0
    buffer_load_dwordx4 v61, s[8:11], s31 offen offset:0 lds
    s_setprio 2
    s_add_u32 s31, s31, 0x1c000
    s_cmp_eq_u32 s31, 0x1c0000
    s_cselect_b32 s31, 0x0, s31
    s_add_u32 m0, s29, 0x4000
    s_setprio 0
    buffer_load_dwordx4 v61, s[8:11], s31 offen offset:0 lds
    s_setprio 2
    s_add_u32 s31, s31, 0x1c000
    s_cmp_eq_u32 s31, 0x1c0000
    s_cselect_b32 s31, 0x0, s31
    s_add_u32 m0, s29, 0x8000
    s_setprio 0
    buffer_load_dwordx4 v61, s[8:11], s31 offen offset:0 lds
    s_setprio 2
    s_add_u32 s31, s31, 0x1c000
    s_cmp_eq_u32 s31, 0x1c0000
    s_cselect_b32 s31, 0x0, s31
    s_add_u32 m0, s29, 0xc000
    s_setprio 0
    buffer_load_dwordx4 v61, s[8:11], s31 offen offset:0 lds
    s_setprio 2
    s_lshl_b32 s64, s70, 6
    s_add_u32 s64, s64, 3072
    v_lshlrev_b32 v69, 2, v1
    s_cmp_lg_u32 s34, 0
    s_cbranch_scc1 L_mid_kernel_ps_5
    s_mov_b32 s66, 0xffff
    s_mov_b32 s67, 0
    s_mov_b32 s65, 0
    s_mov_b64 exec, s[66:67]
L_mid_kernel_pl_3:
    buffer_load_dword v70, v69, s[72:75], s64 offen sc1
    s_waitcnt vmcnt(0)
    v_cmp_ne_u32 vcc, 0, v70
    s_add_u32 s65, s65, 1
    s_cmp_eq_u64 vcc, s[66:67]
    s_cbranch_scc1 L_mid_kernel_pd_4
    s_sleep 3
    s_cmp_lt_u32 s65, 0x100000
    s_cbranch_scc1 L_mid_kernel_pl_3
L_mid_kernel_pd_4:
    s_mov_b64 exec, -1
L_mid_kernel_ps_5:
    s_barrier
    s_mul_i32 s30, s79, 0x20000
    s_add_u32 m0, s28, 0x0
    s_setprio 0
    buffer_load_dwordx4 v60, s[4:7], s30 offen offset:0 sc1 lds
    s_setprio 2
    s_add_u32 s30, s30, 0x20000
    s_cmp_eq_u32 s30, 0x200000
    s_cselect_b32 s30, 0x0, s30
    s_add_u32 m0, s28, 0x4000
    s_setprio 0
    buffer_load_dwordx4 v60, s[4:7], s30 offen offset:0 sc1 lds
    s_setprio 2
    s_add_u32 s30, s30, 0x20000
    s_cmp_eq_u32 s30, 0x200000
    s_cselect_b32 s30, 0x0, s30
    s_add_u32 m0, s28, 0x8000
    s_setprio 0
    buffer_load_dwordx4 v60, s[4:7], s30 offen offset:0 sc1 lds
    s_setprio 2
    s_add_u32 s30, s30, 0x20000
    s_cmp_eq_u32 s30, 0x200000
    s_cselect_b32 s30, 0x0, s30
    s_add_u32 m0, s28, 0xc000
    s_setprio 0
    buffer_load_dwordx4 v60, s[4:7], s30 offen offset:0 sc1 lds
    s_setprio 2
    s_waitcnt vmcnt(3)
    s_barrier
    ds_read_b128 v[36:39], v62 offset:0
    ds_read_b64_tr_b16 v[44:45], v63 offset:8192
    ds_read_b64_tr_b16 v[46:47], v63 offset:10240
    ds_read_b64_tr_b16 v[48:49], v64 offset:8192
    ds_read_b64_tr_b16 v[50:51], v64 offset:10240
    s_waitcnt lgkmcnt(0)
    v_mfma_f32_32x32x16_bf16 v[4:19], v[44:47], v[36:39], 0
    ds_read_b128 v[40:43], v62 offset:4096
    ds_read_b64_tr_b16 v[52:53], v63 offset:12288
    ds_read_b64_tr_b16 v[54:55], v63 offset:14336
    ds_read_b64_tr_b16 v[56:57], v64 offset:12288
    ds_read_b64_tr_b16 v[58:59], v64 offset:14336
    v_mfma_f32_32x32x16_bf16 v[20:35], v[48:51], v[36:39], 0
    s_waitcnt vmcnt(2) lgkmcnt(0)
    s_barrier
    v_mfma_f32_32x32x16_bf16 v[4:19], v[52:55], v[40:43], v[4:19]
    ds_read_b128 v[36:39], v62 offset:16384
    ds_read_b64_tr_b16 v[44:45], v63 offset:24576
    ds_read_b64_tr_b16 v[46:47], v63 offset:26624
    ds_read_b64_tr_b16 v[48:49], v64 offset:24576
    ds_read_b64_tr_b16 v[50:51], v64 offset:26624
    s_add_u32 s30, s30, 0x20000
    s_cmp_eq_u32 s30, 0x200000
    s_cselect_b32 s30, 0x0, s30
    s_add_u32 m0, s28, 0x0
    s_setprio 0
    buffer_load_dwordx4 v60, s[4:7], s30 offen offset:0 sc1 lds
    s_setprio 2
    v_mfma_f32_32x32x16_bf16 v[20:35], v[56:59], v[40:43], v[20:35]
    s_waitcnt lgkmcnt(0)
    v_mfma_f32_32x32x16_bf16 v[4:19], v[44:47], v[36:39], v[4:19]
    ds_read_b128 v[40:43], v62 offset:20480
    ds_read_b64_tr_b16 v[52:53], v63 offset:28672
    ds_read_b64_tr_b16 v[54:55], v63 offset:30720
    ds_read_b64_tr_b16 v[56:57], v64 offset:28672
    ds_read_b64_tr_b16 v[58:59], v64 offset:30720
    s_add_u32 s31, s31, 0x1c000
    s_cmp_eq_u32 s31, 0x1c0000
    s_cselect_b32 s31, 0x0, s31
    s_add_u32 m0, s29, 0x0
    s_setprio 0
    buffer_load_dwordx4 v61, s[8:11], s31 offen offset:0 lds
    s_setprio 2
    v_mfma_f32_32x32x16_bf16 v[20:35], v[48:51], v[36:39], v[20:35]
    s_waitcnt vmcnt(3) lgkmcnt(0)
    s_barrier
    v_mfma_f32_32x32x16_bf16 v[4:19], v[52:55], v[40:43], v[4:19]
    ds_read_b128 v[36:39], v62 offset:32768
    ds_read_b64_tr_b16 v[44:45], v63 offset:40960
    ds_read_b64_tr_b16 v[46:47], v63 offset:43008
    ds_read_b64_tr_b16 v[48:49], v64 offset:40960
    ds_read_b64_tr_b16 v[50:51], v64 offset:43008
    s_add_u32 s30, s30, 0x20000
    s_cmp_eq_u32 s30, 0x200000
    s_cselect_b32 s30, 0x0, s30
    s_add_u32 m0, s28, 0x4000
    s_setprio 0
    buffer_load_dwordx4 v60, s[4:7], s30 offen offset:0 sc1 lds
    s_setprio 2
    v_mfma_f32_32x32x16_bf16 v[20:35], v[56:59], v[40:43], v[20:35]
    s_waitcnt lgkmcnt(0)
    v_mfma_f32_32x32x16_bf16 v[4:19], v[44:47], v[36:39], v[4:19]
    ds_read_b128 v[40:43], v62 offset:36864
    ds_read_b64_tr_b16 v[52:53], v63 offset:45056
    ds_read_b64_tr_b16 v[54:55], v63 offset:47104
    ds_read_b64_tr_b16 v[56:57], v64 offset:45056
    ds_read_b64_tr_b16 v[58:59], v64 offset:47104
    s_add_u32 s31, s31, 0x1c000
    s_cmp_eq_u32 s31, 0x1c0000
    s_cselect_b32 s31, 0x0, s31
    s_add_u32 m0, s29, 0x4000
    s_setprio 0
    buffer_load_dwordx4 v61, s[8:11], s31 offen offset:0 lds
    s_setprio 2
    v_mfma_f32_32x32x16_bf16 v[20:35], v[48:51], v[36:39], v[20:35]
    s_waitcnt vmcnt(4) lgkmcnt(0)
    s_barrier
    v_mfma_f32_32x32x16_bf16 v[4:19], v[52:55], v[40:43], v[4:19]
    ds_read_b128 v[36:39], v62 offset:49152
    ds_read_b64_tr_b16 v[44:45], v63 offset:57344
    ds_read_b64_tr_b16 v[46:47], v63 offset:59392
    ds_read_b64_tr_b16 v[48:49], v64 offset:57344
    ds_read_b64_tr_b16 v[50:51], v64 offset:59392
    s_add_u32 s30, s30, 0x20000
    s_cmp_eq_u32 s30, 0x200000
    s_cselect_b32 s30, 0x0, s30
    s_add_u32 m0, s28, 0x8000
    s_setprio 0
    buffer_load_dwordx4 v60, s[4:7], s30 offen offset:0 sc1 lds
    s_setprio 2
    v_mfma_f32_32x32x16_bf16 v[20:35], v[56:59], v[40:43], v[20:35]
    s_waitcnt lgkmcnt(0)
    v_mfma_f32_32x32x16_bf16 v[4:19], v[44:47], v[36:39], v[4:19]
    ds_read_b128 v[40:43], v62 offset:53248
    ds_read_b64_tr_b16 v[52:53], v63 offset:61440
    ds_read_b64_tr_b16 v[54:55], v63 offset:63488
    ds_read_b64_tr_b16 v[56:57], v64 offset:61440
    ds_read_b64_tr_b16 v[58:59], v64 offset:63488
    s_add_u32 s31, s31, 0x1c000
    s_cmp_eq_u32 s31, 0x1c0000
    s_cselect_b32 s31, 0x0, s31
    s_add_u32 m0, s29, 0x8000
    s_setprio 0
    buffer_load_dwordx4 v61, s[8:11], s31 offen offset:0 lds
    s_setprio 2
    v_mfma_f32_32x32x16_bf16 v[20:35], v[48:51], v[36:39], v[20:35]
    s_waitcnt vmcnt(4) lgkmcnt(0)
    s_barrier
    v_mfma_f32_32x32x16_bf16 v[4:19], v[52:55], v[40:43], v[4:19]
    ds_read_b128 v[36:39], v62 offset:0
    ds_read_b64_tr_b16 v[44:45], v63 offset:8192
    ds_read_b64_tr_b16 v[46:47], v63 offset:10240
    ds_read_b64_tr_b16 v[48:49], v64 offset:8192
    ds_read_b64_tr_b16 v[50:51], v64 offset:10240
    s_add_u32 s30, s30, 0x20000
    s_cmp_eq_u32 s30, 0x200000
    s_cselect_b32 s30, 0x0, s30
    s_add_u32 m0, s28, 0xc000
    s_setprio 0
    buffer_load_dwordx4 v60, s[4:7], s30 offen offset:0 sc1 lds
    s_setprio 2
    v_mfma_f32_32x32x16_bf16 v[20:35], v[56:59], v[40:43], v[20:35]
    s_waitcnt lgkmcnt(0)
    v_mfma_f32_32x32x16_bf16 v[4:19], v[44:47], v[36:39], v[4:19]
    ds_read_b128 v[40:43], v62 offset:4096
    ds_read_b64_tr_b16 v[52:53], v63 offset:12288
    ds_read_b64_tr_b16 v[54:55], v63 offset:14336
    ds_read_b64_tr_b16 v[56:57], v64 offset:12288
    ds_read_b64_tr_b16 v[58:59], v64 offset:14336
    s_add_u32 s31, s31, 0x1c000
    s_cmp_eq_u32 s31, 0x1c0000
    s_cselect_b32 s31, 0x0, s31
    s_add_u32 m0, s29, 0xc000
    s_setprio 0
    buffer_load_dwordx4 v61, s[8:11], s31 offen offset:0 lds
    s_setprio 2
    v_mfma_f32_32x32x16_bf16 v[20:35], v[48:51], v[36:39], v[20:35]
    buffer_load_dwordx4 v[104:107], v67, s[16:19], s80 offen offset:0 sc1
    s_waitcnt vmcnt(5) lgkmcnt(0)
    s_barrier
    v_mfma_f32_32x32x16_bf16 v[4:19], v[52:55], v[40:43], v[4:19]
    ds_read_b128 v[36:39], v62 offset:16384
    ds_read_b64_tr_b16 v[44:45], v63 offset:24576
    ds_read_b64_tr_b16 v[46:47], v63 offset:26624
    ds_read_b64_tr_b16 v[48:49], v64 offset:24576
    ds_read_b64_tr_b16 v[50:51], v64 offset:26624
    s_add_u32 s30, s30, 0x20000
    s_cmp_eq_u32 s30, 0x200000
    s_cselect_b32 s30, 0x0, s30
    s_add_u32 m0, s28, 0x0
    s_setprio 0
    buffer_load_dwordx4 v60, s[4:7], s30 offen offset:0 sc1 lds
    s_setprio 2
    v_mfma_f32_32x32x16_bf16 v[20:35], v[56:59], v[40:43], v[20:35]
    buffer_load_dwordx4 v[108:111], v67, s[16:19], s80 offen offset:512 sc1
    s_waitcnt lgkmcnt(0)
    v_mfma_f32_32x32x16_bf16 v[4:19], v[44:47], v[36:39], v[4:19]
    ds_read_b128 v[40:43], v62 offset:20480
    ds_read_b64_tr_b16 v[52:53], v63 offset:28672
    ds_read_b64_tr_b16 v[54:55], v63 offset:30720
    ds_read_b64_tr_b16 v[56:57], v64 offset:28672
    ds_read_b64_tr_b16 v[58:59], v64 offset:30720
    s_add_u32 s31, s31, 0x1c000
    s_cmp_eq_u32 s31, 0x1c0000
    s_cselect_b32 s31, 0x0, s31
    s_add_u32 m0, s29, 0x0
    s_setprio 0
    buffer_load_dwordx4 v61, s[8:11], s31 offen offset:0 lds
    s_setprio 2
    v_mfma_f32_32x32x16_bf16 v[20:35], v[48:51], v[36:39], v[20:35]
    buffer_load_dwordx4 v[112:115], v67, s[16:19], s80 offen offset:1024 sc1
    s_waitcnt vmcnt(7) lgkmcnt(0)
    s_barrier
    v_mfma_f32_32x32x16_bf16 v[4:19], v[52:55], v[40:43], v[4:19]
    ds_read_b128 v[36:39], v62 offset:32768
    ds_read_b64_tr_b16 v[44:45], v63 offset:40960
    ds_read_b64_tr_b16 v[46:47], v63 offset:43008
    ds_read_b64_tr_b16 v[48:49], v64 offset:40960
    ds_read_b64_tr_b16 v[50:51], v64 offset:43008
    s_add_u32 s30, s30, 0x20000
    s_cmp_eq_u32 s30, 0x200000
    s_cselect_b32 s30, 0x0, s30
    s_add_u32 m0, s28, 0x4000
    s_setprio 0
    buffer_load_dwordx4 v60, s[4:7], s30 offen offset:0 sc1 lds
    s_setprio 2
    v_mfma_f32_32x32x16_bf16 v[20:35], v[56:59], v[40:43], v[20:35]
    buffer_load_dwordx4 v[116:119], v67, s[16:19], s80 offen offset:1536 sc1
    s_waitcnt lgkmcnt(0)
    v_mfma_f32_32x32x16_bf16 v[4:19], v[44:47], v[36:39], v[4:19]
    ds_read_b128 v[40:43], v62 offset:36864
    ds_read_b64_tr_b16 v[52:53], v63 offset:45056
    ds_read_b64_tr_b16 v[54:55], v63 offset:47104
    ds_read_b64_tr_b16 v[56:57], v64 offset:45056
    ds_read_b64_tr_b16 v[58:59], v64 offset:47104
    s_add_u32 s31, s31, 0x1c000
    s_cmp_eq_u32 s31, 0x1c0000
    s_cselect_b32 s31, 0x0, s31
    s_add_u32 m0, s29, 0x4000
    s_setprio 0
    buffer_load_dwordx4 v61, s[8:11], s31 offen offset:0 lds
    s_setprio 2
    v_mfma_f32_32x32x16_bf16 v[20:35], v[48:51], v[36:39], v[20:35]
    buffer_load_dwordx4 v[72:75], v68, s[20:23], s81 offen offset:0
    s_waitcnt vmcnt(9) lgkmcnt(0)
    s_barrier
    v_mfma_f32_32x32x16_bf16 v[4:19], v[52:55], v[40:43], v[4:19]
    ds_read_b128 v[36:39], v62 offset:49152
    ds_read_b64_tr_b16 v[44:45], v63 offset:57344
    ds_read_b64_tr_b16 v[46:47], v63 offset:59392
    ds_read_b64_tr_b16 v[48:49], v64 offset:57344
    ds_read_b64_tr_b16 v[50:51], v64 offset:59392
    s_add_u32 s30, s30, 0x20000
    s_cmp_eq_u32 s30, 0x200000
    s_cselect_b32 s30, 0x0, s30
    s_add_u32 m0, s28, 0x8000
    s_setprio 0
    buffer_load_dwordx4 v60, s[4:7], s30 offen offset:0 sc1 lds
    s_setprio 2
    v_mfma_f32_32x32x16_bf16 v[20:35], v[56:59], v[40:43], v[20:35]
    buffer_load_dwordx4 v[76:79], v68, s[20:23], s81 offen offset:32
    s_waitcnt lgkmcnt(0)
    v_mfma_f32_32x32x16_bf16 v[4:19], v[44:47], v[36:39], v[4:19]
    ds_read_b128 v[40:43], v62 offset:53248
    ds_read_b64_tr_b16 v[52:53], v63 offset:61440
    ds_read_b64_tr_b16 v[54:55], v63 offset:63488
    ds_read_b64_tr_b16 v[56:57], v64 offset:61440
    ds_read_b64_tr_b16 v[58:59], v64 offset:63488
    s_add_u32 s31, s31, 0x1c000
    s_cmp_eq_u32 s31, 0x1c0000
    s_cselect_b32 s31, 0x0, s31
    s_add_u32 m0, s29, 0x8000
    s_setprio 0
    buffer_load_dwordx4 v61, s[8:11], s31 offen offset:0 lds
    s_setprio 2
    v_mfma_f32_32x32x16_bf16 v[20:35], v[48:51], v[36:39], v[20:35]
    buffer_load_dwordx4 v[80:83], v68, s[20:23], s81 offen offset:64
    s_waitcnt vmcnt(9) lgkmcnt(0)
    s_barrier
    v_mfma_f32_32x32x16_bf16 v[4:19], v[52:55], v[40:43], v[4:19]
    ds_read_b128 v[36:39], v62 offset:0
    ds_read_b64_tr_b16 v[44:45], v63 offset:8192
    ds_read_b64_tr_b16 v[46:47], v63 offset:10240
    ds_read_b64_tr_b16 v[48:49], v64 offset:8192
    ds_read_b64_tr_b16 v[50:51], v64 offset:10240
    s_add_u32 s30, s30, 0x20000
    s_cmp_eq_u32 s30, 0x200000
    s_cselect_b32 s30, 0x0, s30
    s_add_u32 m0, s28, 0xc000
    s_setprio 0
    buffer_load_dwordx4 v60, s[4:7], s30 offen offset:0 sc1 lds
    s_setprio 2
    v_mfma_f32_32x32x16_bf16 v[20:35], v[56:59], v[40:43], v[20:35]
    buffer_load_dwordx4 v[84:87], v68, s[20:23], s81 offen offset:96
    s_waitcnt lgkmcnt(0)
    v_mfma_f32_32x32x16_bf16 v[4:19], v[44:47], v[36:39], v[4:19]
    ds_read_b128 v[40:43], v62 offset:4096
    ds_read_b64_tr_b16 v[52:53], v63 offset:12288
    ds_read_b64_tr_b16 v[54:55], v63 offset:14336
    ds_read_b64_tr_b16 v[56:57], v64 offset:12288
    ds_read_b64_tr_b16 v[58:59], v64 offset:14336
    s_add_u32 s31, s31, 0x1c000
    s_cmp_eq_u32 s31, 0x1c0000
    s_cselect_b32 s31, 0x0, s31
    s_add_u32 m0, s29, 0xc000
    s_setprio 0
    buffer_load_dwordx4 v61, s[8:11], s31 offen offset:0 lds
    s_setprio 2
    v_mfma_f32_32x32x16_bf16 v[20:35], v[48:51], v[36:39], v[20:35]
    buffer_load_dwordx4 v[88:91], v68, s[20:23], s81 offen offset:128
    s_waitcnt vmcnt(9) lgkmcnt(0)
    s_barrier
    v_mfma_f32_32x32x16_bf16 v[4:19], v[52:55], v[40:43], v[4:19]
    ds_read_b128 v[36:39], v62 offset:16384
    ds_read_b64_tr_b16 v[44:45], v63 offset:24576
    ds_read_b64_tr_b16 v[46:47], v63 offset:26624
    ds_read_b64_tr_b16 v[48:49], v64 offset:24576
    ds_read_b64_tr_b16 v[50:51], v64 offset:26624
    s_add_u32 s30, s30, 0x20000
    s_cmp_eq_u32 s30, 0x200000
    s_cselect_b32 s30, 0x0, s30
    s_add_u32 m0, s28, 0x0
    s_setprio 0
    buffer_load_dwordx4 v60, s[4:7], s30 offen offset:0 sc1 lds
    s_setprio 2
    v_mfma_f32_32x32x16_bf16 v[20:35], v[56:59], v[40:43], v[20:35]
    buffer_load_dwordx4 v[92:95], v68, s[20:23], s81 offen offset:160
    s_waitcnt lgkmcnt(0)
    v_mfma_f32_32x32x16_bf16 v[4:19], v[44:47], v[36:39], v[4:19]
    ds_read_b128 v[40:43], v62 offset:20480
    ds_read_b64_tr_b16 v[52:53], v63 offset:28672
    ds_read_b64_tr_b16 v[54:55], v63 offset:30720
    ds_read_b64_tr_b16 v[56:57], v64 offset:28672
    ds_read_b64_tr_b16 v[58:59], v64 offset:30720
    s_add_u32 s31, s31, 0x1c000
    s_cmp_eq_u32 s31, 0x1c0000
    s_cselect_b32 s31, 0x0, s31
    s_add_u32 m0, s29, 0x0
    s_setprio 0
    buffer_load_dwordx4 v61, s[8:11], s31 offen offset:0 lds
    s_setprio 2
    v_mfma_f32_32x32x16_bf16 v[20:35], v[48:51], v[36:39], v[20:35]
    buffer_load_dwordx4 v[96:99], v68, s[20:23], s81 offen offset:192
    s_waitcnt vmcnt(9) lgkmcnt(0)
    s_barrier
    v_mfma_f32_32x32x16_bf16 v[4:19], v[52:55], v[40:43], v[4:19]
    ds_read_b128 v[36:39], v62 offset:32768
    ds_read_b64_tr_b16 v[44:45], v63 offset:40960
    ds_read_b64_tr_b16 v[46:47], v63 offset:43008
    ds_read_b64_tr_b16 v[48:49], v64 offset:40960
    ds_read_b64_tr_b16 v[50:51], v64 offset:43008
    s_add_u32 s30, s30, 0x20000
    s_cmp_eq_u32 s30, 0x200000
    s_cselect_b32 s30, 0x0, s30
    s_add_u32 m0, s28, 0x4000
    s_setprio 0
    buffer_load_dwordx4 v60, s[4:7], s30 offen offset:0 sc1 lds
    s_setprio 2
    v_mfma_f32_32x32x16_bf16 v[20:35], v[56:59], v[40:43], v[20:35]
    buffer_load_dwordx4 v[100:103], v68, s[20:23], s81 offen offset:224
    s_waitcnt lgkmcnt(0)
    v_mfma_f32_32x32x16_bf16 v[4:19], v[44:47], v[36:39], v[4:19]
    ds_read_b128 v[40:43], v62 offset:36864
    ds_read_b64_tr_b16 v[52:53], v63 offset:45056
    ds_read_b64_tr_b16 v[54:55], v63 offset:47104
    ds_read_b64_tr_b16 v[56:57], v64 offset:45056
    ds_read_b64_tr_b16 v[58:59], v64 offset:47104
    s_add_u32 s31, s31, 0x1c000
    s_cmp_eq_u32 s31, 0x1c0000
    s_cselect_b32 s31, 0x0, s31
    s_add_u32 m0, s29, 0x4000
    s_setprio 0
    buffer_load_dwordx4 v61, s[8:11], s31 offen offset:0 lds
    s_setprio 2
    v_mfma_f32_32x32x16_bf16 v[20:35], v[48:51], v[36:39], v[20:35]
    s_waitcnt vmcnt(8) lgkmcnt(0)
    s_barrier
    v_mfma_f32_32x32x16_bf16 v[4:19], v[52:55], v[40:43], v[4:19]
    ds_read_b128 v[36:39], v62 offset:49152
    ds_read_b64_tr_b16 v[44:45], v63 offset:57344
    ds_read_b64_tr_b16 v[46:47], v63 offset:59392
    ds_read_b64_tr_b16 v[48:49], v64 offset:57344
    ds_read_b64_tr_b16 v[50:51], v64 offset:59392
    s_add_u32 s30, s30, 0x20000
    s_cmp_eq_u32 s30, 0x200000
    s_cselect_b32 s30, 0x0, s30
    s_add_u32 m0, s28, 0x8000
    s_setprio 0
    buffer_load_dwordx4 v60, s[4:7], s30 offen offset:0 sc1 lds
    s_setprio 2
    v_mfma_f32_32x32x16_bf16 v[20:35], v[56:59], v[40:43], v[20:35]
    s_waitcnt lgkmcnt(0)
    v_mfma_f32_32x32x16_bf16 v[4:19], v[44:47], v[36:39], v[4:19]
    ds_read_b128 v[40:43], v62 offset:53248
    ds_read_b64_tr_b16 v[52:53], v63 offset:61440
    ds_read_b64_tr_b16 v[54:55], v63 offset:63488
    ds_read_b64_tr_b16 v[56:57], v64 offset:61440
    ds_read_b64_tr_b16 v[58:59], v64 offset:63488
    s_add_u32 s31, s31, 0x1c000
    s_cmp_eq_u32 s31, 0x1c0000
    s_cselect_b32 s31, 0x0, s31
    s_add_u32 m0, s29, 0x8000
    s_setprio 0
    buffer_load_dwordx4 v61, s[8:11], s31 offen offset:0 lds
    s_setprio 2
    v_mfma_f32_32x32x16_bf16 v[20:35], v[48:51], v[36:39], v[20:35]
    s_waitcnt vmcnt(6) lgkmcnt(0)
    s_barrier
    v_mfma_f32_32x32x16_bf16 v[4:19], v[52:55], v[40:43], v[4:19]
    ds_read_b128 v[36:39], v62 offset:0
    ds_read_b64_tr_b16 v[44:45], v63 offset:8192
    ds_read_b64_tr_b16 v[46:47], v63 offset:10240
    ds_read_b64_tr_b16 v[48:49], v64 offset:8192
    ds_read_b64_tr_b16 v[50:51], v64 offset:10240
    s_add_u32 s30, s30, 0x20000
    s_cmp_eq_u32 s30, 0x200000
    s_cselect_b32 s30, 0x0, s30
    s_add_u32 m0, s28, 0xc000
    s_setprio 0
    buffer_load_dwordx4 v60, s[4:7], s30 offen offset:0 sc1 lds
    s_setprio 2
    v_mfma_f32_32x32x16_bf16 v[20:35], v[56:59], v[40:43], v[20:35]
    s_waitcnt lgkmcnt(0)
    v_mfma_f32_32x32x16_bf16 v[4:19], v[44:47], v[36:39], v[4:19]
    ds_read_b128 v[40:43], v62 offset:4096
    ds_read_b64_tr_b16 v[52:53], v63 offset:12288
    ds_read_b64_tr_b16 v[54:55], v63 offset:14336
    ds_read_b64_tr_b16 v[56:57], v64 offset:12288
    ds_read_b64_tr_b16 v[58:59], v64 offset:14336
    s_add_u32 s31, s31, 0x1c000
    s_cmp_eq_u32 s31, 0x1c0000
    s_cselect_b32 s31, 0x0, s31
    s_add_u32 m0, s29, 0xc000
    s_setprio 0
    buffer_load_dwordx4 v61, s[8:11], s31 offen offset:0 lds
    s_setprio 2
    v_mfma_f32_32x32x16_bf16 v[20:35], v[48:51], v[36:39], v[20:35]
    s_waitcnt vmcnt(4) lgkmcnt(0)
    s_barrier
    v_mfma_f32_32x32x16_bf16 v[4:19], v[52:55], v[40:43], v[4:19]
    ds_read_b128 v[36:39], v62 offset:16384
    ds_read_b64_tr_b16 v[44:45], v63 offset:24576
    ds_read_b64_tr_b16 v[46:47], v63 offset:26624
    ds_read_b64_tr_b16 v[48:49], v64 offset:24576
    ds_read_b64_tr_b16 v[50:51], v64 offset:26624
    v_mfma_f32_32x32x16_bf16 v[20:35], v[56:59], v[40:43], v[20:35]
    s_waitcnt lgkmcnt(0)
    v_mfma_f32_32x32x16_bf16 v[4:19], v[44:47], v[36:39], v[4:19]
    ds_read_b128 v[40:43], v62 offset:20480
    ds_read_b64_tr_b16 v[52:53], v63 offset:28672
    ds_read_b64_tr_b16 v[54:55], v63 offset:30720
    ds_read_b64_tr_b16 v[56:57], v64 offset:28672
    ds_read_b64_tr_b16 v[58:59], v64 offset:30720
    v_mfma_f32_32x32x16_bf16 v[20:35], v[48:51], v[36:39], v[20:35]
    s_waitcnt vmcnt(2) lgkmcnt(0)
    s_barrier
    v_mfma_f32_32x32x16_bf16 v[4:19], v[52:55], v[40:43], v[4:19]
    ds_read_b128 v[36:39], v62 offset:32768
    ds_read_b64_tr_b16 v[44:45], v63 offset:40960
    ds_read_b64_tr_b16 v[46:47], v63 offset:43008
    ds_read_b64_tr_b16 v[48:49], v64 offset:40960
    ds_read_b64_tr_b16 v[50:51], v64 offset:43008
    v_mfma_f32_32x32x16_bf16 v[20:35], v[56:59], v[40:43], v[20:35]
    s_waitcnt lgkmcnt(0)
    v_mfma_f32_32x32x16_bf16 v[4:19], v[44:47], v[36:39], v[4:19]
    ds_read_b128 v[40:43], v62 offset:36864
    ds_read_b64_tr_b16 v[52:53], v63 offset:45056
    ds_read_b64_tr_b16 v[54:55], v63 offset:47104
    ds_read_b64_tr_b16 v[56:57], v64 offset:45056
    ds_read_b64_tr_b16 v[58:59], v64 offset:47104
    v_mfma_f32_32x32x16_bf16 v[20:35], v[48:51], v[36:39], v[20:35]
    s_waitcnt vmcnt(0) lgkmcnt(0)
    s_barrier
    v_mfma_f32_32x32x16_bf16 v[4:19], v[52:55], v[40:43], v[4:19]
    ds_read_b128 v[36:39], v62 offset:49152
    ds_read_b64_tr_b16 v[44:45], v63 offset:57344
    ds_read_b64_tr_b16 v[46:47], v63 offset:59392
    ds_read_b64_tr_b16 v[48:49], v64 offset:57344
    ds_read_b64_tr_b16 v[50:51], v64 offset:59392
    v_mfma_f32_32x32x16_bf16 v[20:35], v[56:59], v[40:43], v[20:35]
    s_waitcnt lgkmcnt(0)
    v_mfma_f32_32x32x16_bf16 v[4:19], v[44:47], v[36:39], v[4:19]
    ds_read_b128 v[40:43], v62 offset:53248
    ds_read_b64_tr_b16 v[52:53], v63 offset:61440
    ds_read_b64_tr_b16 v[54:55], v63 offset:63488
    ds_read_b64_tr_b16 v[56:57], v64 offset:61440
    ds_read_b64_tr_b16 v[58:59], v64 offset:63488
    v_mfma_f32_32x32x16_bf16 v[20:35], v[48:51], v[36:39], v[20:35]
    s_waitcnt lgkmcnt(0)
    v_mfma_f32_32x32x16_bf16 v[4:19], v[52:55], v[40:43], v[4:19]
    v_mfma_f32_32x32x16_bf16 v[20:35], v[56:59], v[40:43], v[20:35]
    s_waitcnt vmcnt(0)
    v_add_f32 v120, v104, v106
    v_add_f32 v122, v105, v107
    v_add_f32 v120, v120, v108
    v_add_f32 v122, v122, v109
    v_add_f32 v120, v120, v110
    v_add_f32 v122, v122, v111
    v_add_f32 v120, v120, v112
    v_add_f32 v122, v122, v113
    v_add_f32 v120, v120, v114
    v_add_f32 v122, v122, v115
    v_add_f32 v120, v120, v116
    v_add_f32 v122, v122, v117
    v_add_f32 v120, v120, v118
    v_add_f32 v122, v122, v119
    v_mov_b32 v121, v120
    v_mov_b32 v123, v122
    s_nop 1
    v_permlane32_swap_b32 v120, v121
    v_permlane32_swap_b32 v122, v123
    s_nop 1
    v_add_f32 v120, v120, v121
    v_add_f32 v122, v122, v123
    v_mul_f32 v120, 0xbb000000, v120
    v_mul_f32 v122, 0x3b000000, v122
    v_fma_f32 v122, -v120, v120, v122
    v_max_f32 v122, 0, v122
    v_add_f32 v122, 0x3727c5ac, v122
    v_rsq_f32 v122, v122
    v_mov_b32 v52, 0xc0135761
    v_mov_b32 v54, 0xbdd2d3e8
    v_mov_b32 v56, 1.0
    v_pk_fma_f32 v[4:5], v[72:73], v[120:121], v[4:5] op_sel_hi:[1,0,1]
    v_pk_fma_f32 v[6:7], v[74:75], v[120:121], v[6:7] op_sel_hi:[1,0,1]
    v_pk_fma_f32 v[8:9], v[76:77], v[120:121], v[8:9] op_sel_hi:[1,0,1]
    v_pk_fma_f32 v[10:11], v[78:79], v[120:121], v[10:11] op_sel_hi:[1,0,1]
    v_pk_mul_f32 v[4:5], v[4:5], v[122:123] op_sel_hi:[1,0]
    v_pk_mul_f32 v[6:7], v[6:7], v[122:123] op_sel_hi:[1,0]
    v_pk_mul_f32 v[8:9], v[8:9], v[122:123] op_sel_hi:[1,0]
    v_pk_mul_f32 v[10:11], v[10:11], v[122:123] op_sel_hi:[1,0]
    v_pk_mul_f32 v[44:45], v[4:5], v[4:5]
    v_pk_mul_f32 v[46:47], v[6:7], v[6:7]
    v_pk_mul_f32 v[48:49], v[8:9], v[8:9]
    v_pk_mul_f32 v[50:51], v[10:11], v[10:11]
    v_pk_fma_f32 v[44:45], v[44:45], v[54:55], v[52:53] op_sel_hi:[1,0,0]
    v_pk_fma_f32 v[46:47], v[46:47], v[54:55], v[52:53] op_sel_hi:[1,0,0]
    v_pk_fma_f32 v[48:49], v[48:49], v[54:55], v[52:53] op_sel_hi:[1,0,0]
    v_pk_fma_f32 v[50:51], v[50:51], v[54:55], v[52:53] op_sel_hi:[1,0,0]
    v_pk_mul_f32 v[44:45], v[44:45], v[4:5]
    v_pk_mul_f32 v[46:47], v[46:47], v[6:7]
    v_pk_mul_f32 v[48:49], v[48:49], v[8:9]
    v_pk_mul_f32 v[50:51], v[50:51], v[10:11]
    v_exp_f32 v44, v44
    v_exp_f32 v46, v46
    v_exp_f32 v48, v48
    v_exp_f32 v50, v50
    v_exp_f32 v45, v45
    v_exp_f32 v47, v47
    v_exp_f32 v49, v49
    v_exp_f32 v51, v51
    v_pk_add_f32 v[44:45], v[44:45], v[56:57] op_sel_hi:[1,0]
    v_pk_add_f32 v[46:47], v[46:47], v[56:57] op_sel_hi:[1,0]
    v_pk_add_f32 v[48:49], v[48:49], v[56:57] op_sel_hi:[1,0]
    v_pk_add_f32 v[50:51], v[50:51], v[56:57] op_sel_hi:[1,0]
    v_rcp_f32 v44, v44
    v_rcp_f32 v46, v46
    v_rcp_f32 v48, v48
    v_rcp_f32 v50, v50
    v_rcp_f32 v45, v45
    v_rcp_f32 v47, v47
    v_rcp_f32 v49, v49
    v_rcp_f32 v51, v51
    v_pk_mul_f32 v[4:5], v[4:5], v[44:45]
    v_pk_mul_f32 v[6:7], v[6:7], v[46:47]
    v_pk_mul_f32 v[8:9], v[8:9], v[48:49]
    v_pk_mul_f32 v[10:11], v[10:11], v[50:51]
    s_add_u32 s65, s83, s68
    v_cvt_pk_bf16_f32 v36, v4, v5
    v_cvt_pk_bf16_f32 v37, v6, v7
    v_cvt_pk_bf16_f32 v38, v8, v9
    v_cvt_pk_bf16_f32 v39, v10, v11
    buffer_store_dwordx4 v[36:39], v124, s[12:15], s65 offen sc1
    v_pk_fma_f32 v[12:13], v[80:81], v[120:121], v[12:13] op_sel_hi:[1,0,1]
    v_pk_fma_f32 v[14:15], v[82:83], v[120:121], v[14:15] op_sel_hi:[1,0,1]
    v_pk_fma_f32 v[16:17], v[84:85], v[120:121], v[16:17] op_sel_hi:[1,0,1]
    v_pk_fma_f32 v[18:19], v[86:87], v[120:121], v[18:19] op_sel_hi:[1,0,1]
    v_pk_mul_f32 v[12:13], v[12:13], v[122:123] op_sel_hi:[1,0]
    v_pk_mul_f32 v[14:15], v[14:15], v[122:123] op_sel_hi:[1,0]
    v_pk_mul_f32 v[16:17], v[16:17], v[122:123] op_sel_hi:[1,0]
    v_pk_mul_f32 v[18:19], v[18:19], v[122:123] op_sel_hi:[1,0]
    v_pk_mul_f32 v[44:45], v[12:13], v[12:13]
    v_pk_mul_f32 v[46:47], v[14:15], v[14:15]
    v_pk_mul_f32 v[48:49], v[16:17], v[16:17]
    v_pk_mul_f32 v[50:51], v[18:19], v[18:19]
    v_pk_fma_f32 v[44:45], v[44:45], v[54:55], v[52:53] op_sel_hi:[1,0,0]
    v_pk_fma_f32 v[46:47], v[46:47], v[54:55], v[52:53] op_sel_hi:[1,0,0]
    v_pk_fma_f32 v[48:49], v[48:49], v[54:55], v[52:53] op_sel_hi:[1,0,0]
    v_pk_fma_f32 v[50:51], v[50:51], v[54:55], v[52:53] op_sel_hi:[1,0,0]
    v_pk_mul_f32 v[44:45], v[44:45], v[12:13]
    v_pk_mul_f32 v[46:47], v[46:47], v[14:15]
    v_pk_mul_f32 v[48:49], v[48:49], v[16:17]
    v_pk_mul_f32 v[50:51], v[50:51], v[18:19]
    v_exp_f32 v44, v44
    v_exp_f32 v46, v46
    v_exp_f32 v48, v48
    v_exp_f32 v50, v50
    v_exp_f32 v45, v45
    v_exp_f32 v47, v47
    v_exp_f32 v49, v49
    v_exp_f32 v51, v51
    v_pk_add_f32 v[44:45], v[44:45], v[56:57] op_sel_hi:[1,0]
    v_pk_add_f32 v[46:47], v[46:47], v[56:57] op_sel_hi:[1,0]
    v_pk_add_f32 v[48:49], v[48:49], v[56:57] op_sel_hi:[1,0]
    v_pk_add_f32 v[50:51], v[50:51], v[56:57] op_sel_hi:[1,0]
    v_rcp_f32 v44, v44
    v_rcp_f32 v46, v46
    v_rcp_f32 v48, v48
    v_rcp_f32 v50, v50
    v_rcp_f32 v45, v45
    v_rcp_f32 v47, v47
    v_rcp_f32 v49, v49
    v_rcp_f32 v51, v51
    v_pk_mul_f32 v[12:13], v[12:13], v[44:45]
    v_pk_mul_f32 v[14:15], v[14:15], v[46:47]
    v_pk_mul_f32 v[16:17], v[16:17], v[48:49]
    v_pk_mul_f32 v[18:19], v[18:19], v[50:51]
    s_add_u32 s65, s65, 0x10000
    v_cvt_pk_bf16_f32 v40, v12, v13
    v_cvt_pk_bf16_f32 v41, v14, v15
    v_cvt_pk_bf16_f32 v42, v16, v17
    v_cvt_pk_bf16_f32 v43, v18, v19
    buffer_store_dwordx4 v[40:43], v124, s[12:15], s65 offen sc1
    v_pk_fma_f32 v[20:21], v[88:89], v[120:121], v[20:21] op_sel_hi:[1,0,1]
    v_pk_fma_f32 v[22:23], v[90:91], v[120:121], v[22:23] op_sel_hi:[1,0,1]
    v_pk_fma_f32 v[24:25], v[92:93], v[120:121], v[24:25] op_sel_hi:[1,0,1]
    v_pk_fma_f32 v[26:27], v[94:95], v[120:121], v[26:27] op_sel_hi:[1,0,1]
    v_pk_mul_f32 v[20:21], v[20:21], v[122:123] op_sel_hi:[1,0]
    v_pk_mul_f32 v[22:23], v[22:23], v[122:123] op_sel_hi:[1,0]
    v_pk_mul_f32 v[24:25], v[24:25], v[122:123] op_sel_hi:[1,0]
    v_pk_mul_f32 v[26:27], v[26:27], v[122:123] op_sel_hi:[1,0]
    v_pk_mul_f32 v[44:45], v[20:21], v[20:21]
    v_pk_mul_f32 v[46:47], v[22:23], v[22:23]
    v_pk_mul_f32 v[48:49], v[24:25], v[24:25]
    v_pk_mul_f32 v[50:51], v[26:27], v[26:27]
    v_pk_fma_f32 v[44:45], v[44:45], v[54:55], v[52:53] op_sel_hi:[1,0,0]
    v_pk_fma_f32 v[46:47], v[46:47], v[54:55], v[52:53] op_sel_hi:[1,0,0]
    v_pk_fma_f32 v[48:49], v[48:49], v[54:55], v[52:53] op_sel_hi:[1,0,0]
    v_pk_fma_f32 v[50:51], v[50:51], v[54:55], v[52:53] op_sel_hi:[1,0,0]
    v_pk_mul_f32 v[44:45], v[44:45], v[20:21]
    v_pk_mul_f32 v[46:47], v[46:47], v[22:23]
    v_pk_mul_f32 v[48:49], v[48:49], v[24:25]
    v_pk_mul_f32 v[50:51], v[50:51], v[26:27]
    v_exp_f32 v44, v44
    v_exp_f32 v46, v46
    v_exp_f32 v48, v48
    v_exp_f32 v50, v50
    v_exp_f32 v45, v45
    v_exp_f32 v47, v47
    v_exp_f32 v49, v49
    v_exp_f32 v51, v51
    v_pk_add_f32 v[44:45], v[44:45], v[56:57] op_sel_hi:[1,0]
    v_pk_add_f32 v[46:47], v[46:47], v[56:57] op_sel_hi:[1,0]
    v_pk_add_f32 v[48:49], v[48:49], v[56:57] op_sel_hi:[1,0]
    v_pk_add_f32 v[50:51], v[50:51], v[56:57] op_sel_hi:[1,0]
    v_rcp_f32 v44, v44
    v_rcp_f32 v46, v46
    v_rcp_f32 v48, v48
    v_rcp_f32 v50, v50
    v_rcp_f32 v45, v45
    v_rcp_f32 v47, v47
    v_rcp_f32 v49, v49
    v_rcp_f32 v51, v51
    v_pk_mul_f32 v[20:21], v[20:21], v[44:45]
    v_pk_mul_f32 v[22:23], v[22:23], v[46:47]
    v_pk_mul_f32 v[24:25], v[24:25], v[48:49]
    v_pk_mul_f32 v[26:27], v[26:27], v[50:51]
    s_add_u32 s65, s83, s69
    v_cvt_pk_bf16_f32 v36, v20, v21
    v_cvt_pk_bf16_f32 v37, v22, v23
    v_cvt_pk_bf16_f32 v38, v24, v25
    v_cvt_pk_bf16_f32 v39, v26, v27
    buffer_store_dwordx4 v[36:39], v124, s[12:15], s65 offen sc1
    v_pk_fma_f32 v[28:29], v[96:97], v[120:121], v[28:29] op_sel_hi:[1,0,1]
    v_pk_fma_f32 v[30:31], v[98:99], v[120:121], v[30:31] op_sel_hi:[1,0,1]
    v_pk_fma_f32 v[32:33], v[100:101], v[120:121], v[32:33] op_sel_hi:[1,0,1]
    v_pk_fma_f32 v[34:35], v[102:103], v[120:121], v[34:35] op_sel_hi:[1,0,1]
    v_pk_mul_f32 v[28:29], v[28:29], v[122:123] op_sel_hi:[1,0]
    v_pk_mul_f32 v[30:31], v[30:31], v[122:123] op_sel_hi:[1,0]
    v_pk_mul_f32 v[32:33], v[32:33], v[122:123] op_sel_hi:[1,0]
    v_pk_mul_f32 v[34:35], v[34:35], v[122:123] op_sel_hi:[1,0]
    v_pk_mul_f32 v[44:45], v[28:29], v[28:29]
    v_pk_mul_f32 v[46:47], v[30:31], v[30:31]
    v_pk_mul_f32 v[48:49], v[32:33], v[32:33]
    v_pk_mul_f32 v[50:51], v[34:35], v[34:35]
    v_pk_fma_f32 v[44:45], v[44:45], v[54:55], v[52:53] op_sel_hi:[1,0,0]
    v_pk_fma_f32 v[46:47], v[46:47], v[54:55], v[52:53] op_sel_hi:[1,0,0]
    v_pk_fma_f32 v[48:49], v[48:49], v[54:55], v[52:53] op_sel_hi:[1,0,0]
    v_pk_fma_f32 v[50:51], v[50:51], v[54:55], v[52:53] op_sel_hi:[1,0,0]
    v_pk_mul_f32 v[44:45], v[44:45], v[28:29]
    v_pk_mul_f32 v[46:47], v[46:47], v[30:31]
    v_pk_mul_f32 v[48:49], v[48:49], v[32:33]
    v_pk_mul_f32 v[50:51], v[50:51], v[34:35]
    v_exp_f32 v44, v44
    v_exp_f32 v46, v46
    v_exp_f32 v48, v48
    v_exp_f32 v50, v50
    v_exp_f32 v45, v45
    v_exp_f32 v47, v47
    v_exp_f32 v49, v49
    v_exp_f32 v51, v51
    v_pk_add_f32 v[44:45], v[44:45], v[56:57] op_sel_hi:[1,0]
    v_pk_add_f32 v[46:47], v[46:47], v[56:57] op_sel_hi:[1,0]
    v_pk_add_f32 v[48:49], v[48:49], v[56:57] op_sel_hi:[1,0]
    v_pk_add_f32 v[50:51], v[50:51], v[56:57] op_sel_hi:[1,0]
    v_rcp_f32 v44, v44
    v_rcp_f32 v46, v46
    v_rcp_f32 v48, v48
    v_rcp_f32 v50, v50
    v_rcp_f32 v45, v45
    v_rcp_f32 v47, v47
    v_rcp_f32 v49, v49
    v_rcp_f32 v51, v51
    v_pk_mul_f32 v[28:29], v[28:29], v[44:45]
    v_pk_mul_f32 v[30:31], v[30:31], v[46:47]
    v_pk_mul_f32 v[32:33], v[32:33], v[48:49]
    v_pk_mul_f32 v[34:35], v[34:35], v[50:51]
    s_add_u32 s65, s65, 0x10000
    v_cvt_pk_bf16_f32 v40, v28, v29
    v_cvt_pk_bf16_f32 v41, v30, v31
    v_cvt_pk_bf16_f32 v42, v32, v33
    v_cvt_pk_bf16_f32 v43, v34, v35
    buffer_store_dwordx4 v[40:43], v124, s[12:15], s65 offen sc1
    s_waitcnt vmcnt(0)
    s_lshl_b32 s64, s70, 7
    s_lshl_b32 s65, s71, 2
    s_add_u32 s64, s64, s65
    s_setprio 0
    s_barrier
    s_cmp_lg_u32 s34, 0
    s_cbranch_scc1 L_mid_kernel_pub_6
    v_mov_b32 v69, 0
    v_mov_b32 v70, 1
    s_mov_b64 exec, 1
    buffer_store_dword v70, v69, s[72:75], s64 offen sc1
    s_mov_b64 exec, -1
L_mid_kernel_pub_6:
    s_branch L_mid_kernel_B_done
L_mid_kernel_B_skip:
    s_setprio 0
L_mid_kernel_B_done:
    v_and_b32 v3, 3, v2
    s_lshl_b32 s37, s35, 2
    s_and_b32 s38, s36, 3
    s_add_u32 s70, s37, s38
    s_lshr_b32 s71, s36, 2
    s_lshl_b32 s32, s70, 6
    s_lshl_b32 s33, s71, 6
    s_lshl_b32 s37, s38, 1
    s_add_u32 s79, s37, s71
    s_and_b32 s79, s79, 7
    s_mul_i32 s68, s79, 7
    s_lshr_b32 s68, s68, 1
    s_add_u32 s4, s62, 0xc00000
    s_addc_u32 s5, s63, 0
    s_mov_b32 s6, 0x700000
    s_mov_b32 s7, 0x20000
    s_mov_b32 s8, s54
    s_mov_b32 s9, s55
    s_mov_b32 s10, 0x1c0000
    s_mov_b32 s11, 0x20000
    s_mov_b32 s12, s58
    s_mov_b32 s13, s59
    s_mov_b32 s14, 0x200000
    s_mov_b32 s15, 0x20000
    s_add_u32 s16, s62, 0x800000
    s_addc_u32 s17, s63, 0
    s_mov_b32 s18, 0x200000
    s_mov_b32 s19, 0x20000
    s_add_u32 s20, s62, 0xa00000
    s_addc_u32 s21, s63, 0
    s_mov_b32 s22, 0x200000
    s_mov_b32 s23, 0x20000
    s_mov_b32 s24, s44
    s_mov_b32 s25, s45
    s_mov_b32 s26, 0x80000
    s_mov_b32 s27, 0x20000
    s_cmp_ge_u32 s34, 4
    s_cbranch_scc1 L_mid_kernel_C_ld
    s_setprio 2
    s_add_u32 s64, s62, 0x1360000
    s_addc_u32 s65, s63, 0
    s_mov_b32 s66, 0x20000
    s_mov_b32 s67, 0x20000
    s_lshr_b32 s37, s34, 1
    s_and_b32 s38, s34, 1
    s_lshl_b32 s39, s37, 5
    s_add_u32 s39, s39, s32
    v_and_b32 v86, 31, v1
    v_add_u32 v86, s39, v86
    v_lshlrev_b32 v84, 10, v86
    s_lshl_b32 s81, s39, 5
    s_lshl_b32 s39, s38, 5
    s_add_u32 s39, s39, s33
    s_lshl_b32 s80, s39, 12
    s_add_u32 s80, s80, s81
    s_add_u32 s81, s80, 0x10000
    s_lshl_b32 s39, s39, 1
    v_add_u32 v84, s39, v84
    v_lshrrev_b32 v88, 5, v1
    v_lshl_add_u32 v85, v88, 3, v84
    v_lshlrev_b32 v84, 4, v1
    v_and_b32 v87, 31, v1
    v_lshlrev_b32 v87, 4, v87
    v_lshl_add_u32 v87, v88, 10, v87
    s_lshl_b32 s39, s70, 1
    s_add_u32 s39, s39, s37
    s_lshl_b32 s39, s39, 11
    v_lshrrev_b32 v78, 1, v2
    v_and_b32 v79, 1, v2
    v_and_b32 v80, 31, v1
    v_lshrrev_b32 v81, 5, v1
    v_mul_u32_u24 v82, 1024, v78
    v_lshl_add_u32 v76, v1, 4, v82
    v_bfe_u32 v80, v1, 2, 2
    v_lshl_add_u32 v82, v81, 2, v80
    v_mul_u32_u24 v82, 128, v82
    v_and_b32 v83, 1, v1
    v_lshl_add_u32 v82, v83, 3, v82
    v_lshrrev_b32 v80, 1, v80
    v_lshlrev_b32 v80, 2, v80
    v_bfe_u32 v83, v1, 4, 1
    v_lshlrev_b32 v83, 1, v83
    v_bfe_u32 v81, v1, 1, 1
    v_add_u32 v83, v83, v81
    v_mul_u32_u24 v81, 4, v79
    v_add_u32 v83, v83, v81
    v_add_u32 v77, 0, v83
    v_xor_b32 v77, v77, v80
    v_lshl_add_u32 v77, v77, 4, v82
    s_barrier
    s_barrier
    ds_read_b128 v[36:39], v76 offset:0
    ds_read_b64_tr_b16 v[52:53], v77 offset:8192
    ds_read_b64_tr_b16 v[54:55], v77 offset:9216
    ds_read_b128 v[40:43], v76 offset:2048
    ds_read_b64_tr_b16 v[56:57], v77 offset:10240
    ds_read_b64_tr_b16 v[58:59], v77 offset:11264
    ds_read_b128 v[44:47], v76 offset:4096
    ds_read_b64_tr_b16 v[60:61], v77 offset:12288
    ds_read_b64_tr_b16 v[62:63], v77 offset:13312
    s_waitcnt lgkmcnt(6)
    v_mfma_f32_32x32x16_bf16 v[4:19], v[52:55], v[36:39], 0
    ds_read_b128 v[48:51], v76 offset:6144
    ds_read_b64_tr_b16 v[64:65], v77 offset:14336
    ds_read_b64_tr_b16 v[66:67], v77 offset:15360
    buffer_load_dwordx4 v[100:103], v87, s[64:67], s39 offen offset:0 sc1
    buffer_load_dwordx4 v[104:107], v87, s[64:67], s39 offen offset:512 sc1
    buffer_load_dwordx4 v[92:95], v84, s[16:19], s80 offen sc1
    buffer_load_dwordx4 v[96:99], v84, s[16:19], s81 offen sc1
    s_waitcnt lgkmcnt(0)
    s_barrier
    v_mfma_f32_32x32x16_bf16 v[4:19], v[56:59], v[40:43], v[4:19]
    ds_read_b128 v[36:39], v76 offset:16384
    ds_read_b64_tr_b16 v[52:53], v77 offset:24576
    ds_read_b64_tr_b16 v[54:55], v77 offset:25600
    s_waitcnt lgkmcnt(6)
    v_mfma_f32_32x32x16_bf16 v[4:19], v[60:63], v[44:47], v[4:19]
    ds_read_b128 v[40:43], v76 offset:18432
    ds_read_b64_tr_b16 v[56:57], v77 offset:26624
    ds_read_b64_tr_b16 v[58:59], v77 offset:27648
    s_waitcnt lgkmcnt(6)
    v_mfma_f32_32x32x16_bf16 v[4:19], v[64:67], v[48:51], v[4:19]
    ds_read_b128 v[44:47], v76 offset:20480
    ds_read_b64_tr_b16 v[60:61], v77 offset:28672
    ds_read_b64_tr_b16 v[62:63], v77 offset:29696
    s_waitcnt lgkmcnt(6)
    v_mfma_f32_32x32x16_bf16 v[4:19], v[52:55], v[36:39], v[4:19]
    ds_read_b128 v[48:51], v76 offset:22528
    ds_read_b64_tr_b16 v[64:65], v77 offset:30720
    ds_read_b64_tr_b16 v[66:67], v77 offset:31744
    s_waitcnt lgkmcnt(0)
    s_barrier
    v_mfma_f32_32x32x16_bf16 v[4:19], v[56:59], v[40:43], v[4:19]
    ds_read_b128 v[36:39], v76 offset:32768
    ds_read_b64_tr_b16 v[52:53], v77 offset:40960
    ds_read_b64_tr_b16 v[54:55], v77 offset:41984
    s_waitcnt lgkmcnt(6)
    v_mfma_f32_32x32x16_bf16 v[4:19], v[60:63], v[44:47], v[4:19]
    ds_read_b128 v[40:43], v76 offset:34816
    ds_read_b64_tr_b16 v[56:57], v77 offset:43008
    ds_read_b64_tr_b16 v[58:59], v77 offset:44032
    s_waitcnt lgkmcnt(6)
    v_mfma_f32_32x32x16_bf16 v[4:19], v[64:67], v[48:51], v[4:19]
    ds_read_b128 v[44:47], v76 offset:36864
    ds_read_b64_tr_b16 v[60:61], v77 offset:45056
    ds_read_b64_tr_b16 v[62:63], v77 offset:46080
    s_waitcnt lgkmcnt(6)
    v_mfma_f32_32x32x16_bf16 v[4:19], v[52:55], v[36:39], v[4:19]
    ds_read_b128 v[48:51], v76 offset:38912
    ds_read_b64_tr_b16 v[64:65], v77 offset:47104
    ds_read_b64_tr_b16 v[66:67], v77 offset:48128
    s_waitcnt lgkmcnt(0)
    s_barrier
    v_mfma_f32_32x32x16_bf16 v[4:19], v[56:59], v[40:43], v[4:19]
    ds_read_b128 v[36:39], v76 offset:49152
    ds_read_b64_tr_b16 v[52:53], v77 offset:57344
    ds_read_b64_tr_b16 v[54:55], v77 offset:58368
    s_waitcnt lgkmcnt(6)
    v_mfma_f32_32x32x16_bf16 v[4:19], v[60:63], v[44:47], v[4:19]
    ds_read_b128 v[40:43], v76 offset:51200
    ds_read_b64_tr_b16 v[56:57], v77 offset:59392
    ds_read_b64_tr_b16 v[58:59], v77 offset:60416
    s_waitcnt lgkmcnt(6)
    v_mfma_f32_32x32x16_bf16 v[4:19], v[64:67], v[48:51], v[4:19]
    ds_read_b128 v[44:47], v76 offset:53248
    ds_read_b64_tr_b16 v[60:61], v77 offset:61440
    ds_read_b64_tr_b16 v[62:63], v77 offset:62464
    s_waitcnt lgkmcnt(6)
    v_mfma_f32_32x32x16_bf16 v[4:19], v[52:55], v[36:39], v[4:19]
    ds_read_b128 v[48:51], v76 offset:55296
    ds_read_b64_tr_b16 v[64:65], v77 offset:63488
    ds_read_b64_tr_b16 v[66:67], v77 offset:64512
    s_waitcnt lgkmcnt(0)
    s_barrier
    v_mfma_f32_32x32x16_bf16 v[4:19], v[56:59], v[40:43], v[4:19]
    ds_read_b128 v[36:39], v76 offset:0
    ds_read_b64_tr_b16 v[52:53], v77 offset:8192
    ds_read_b64_tr_b16 v[54:55], v77 offset:9216
    s_waitcnt lgkmcnt(6)
    v_mfma_f32_32x32x16_bf16 v[4:19], v[60:63], v[44:47], v[4:19]
    ds_read_b128 v[40:43], v76 offset:2048
    ds_read_b64_tr_b16 v[56:57], v77 offset:10240
    ds_read_b64_tr_b16 v[58:59], v77 offset:11264
    s_waitcnt lgkmcnt(6)
    v_mfma_f32_32x32x16_bf16 v[4:19], v[64:67], v[48:51], v[4:19]
    ds_read_b128 v[44:47], v76 offset:4096
    ds_read_b64_tr_b16 v[60:61], v77 offset:12288
    ds_read_b64_tr_b16 v[62:63], v77 offset:13312
    s_waitcnt lgkmcnt(6)
    v_mfma_f32_32x32x16_bf16 v[4:19], v[52:55], v[36:39], v[4:19]
    ds_read_b128 v[48:51], v76 offset:6144
    ds_read_b64_tr_b16 v[64:65], v77 offset:14336
    ds_read_b64_tr_b16 v[66:67], v77 offset:15360
    s_waitcnt lgkmcnt(0)
    s_barrier
    v_mfma_f32_32x32x16_bf16 v[4:19], v[56:59], v[40:43], v[4:19]
    ds_read_b128 v[36:39], v76 offset:16384
    ds_read_b64_tr_b16 v[52:53], v77 offset:24576
    ds_read_b64_tr_b16 v[54:55], v77 offset:25600
    s_waitcnt lgkmcnt(6)
    v_mfma_f32_32x32x16_bf16 v[4:19], v[60:63], v[44:47], v[4:19]
    ds_read_b128 v[40:43], v76 offset:18432
    ds_read_b64_tr_b16 v[56:57], v77 offset:26624
    ds_read_b64_tr_b16 v[58:59], v77 offset:27648
    s_waitcnt lgkmcnt(6)
    v_mfma_f32_32x32x16_bf16 v[4:19], v[64:67], v[48:51], v[4:19]
    ds_read_b128 v[44:47], v76 offset:20480
    ds_read_b64_tr_b16 v[60:61], v77 offset:28672
    ds_read_b64_tr_b16 v[62:63], v77 offset:29696
    s_waitcnt lgkmcnt(6)
    v_mfma_f32_32x32x16_bf16 v[4:19], v[52:55], v[36:39], v[4:19]
    ds_read_b128 v[48:51], v76 offset:22528
    ds_read_b64_tr_b16 v[64:65], v77 offset:30720
    ds_read_b64_tr_b16 v[66:67], v77 offset:31744
    s_waitcnt lgkmcnt(0)
    s_barrier
    v_mfma_f32_32x32x16_bf16 v[4:19], v[56:59], v[40:43], v[4:19]
    ds_read_b128 v[36:39], v76 offset:32768
    ds_read_b64_tr_b16 v[52:53], v77 offset:40960
    ds_read_b64_tr_b16 v[54:55], v77 offset:41984
    s_waitcnt lgkmcnt(6)
    v_mfma_f32_32x32x16_bf16 v[4:19], v[60:63], v[44:47], v[4:19]
    ds_read_b128 v[40:43], v76 offset:34816
    ds_read_b64_tr_b16 v[56:57], v77 offset:43008
    ds_read_b64_tr_b16 v[58:59], v77 offset:44032
    s_waitcnt lgkmcnt(6)
    v_mfma_f32_32x32x16_bf16 v[4:19], v[64:67], v[48:51], v[4:19]
    ds_read_b128 v[44:47], v76 offset:36864
    ds_read_b64_tr_b16 v[60:61], v77 offset:45056
    ds_read_b64_tr_b16 v[62:63], v77 offset:46080
    s_waitcnt lgkmcnt(6)
    v_mfma_f32_32x32x16_bf16 v[4:19], v[52:55], v[36:39], v[4:19]
    ds_read_b128 v[48:51], v76 offset:38912
    ds_read_b64_tr_b16 v[64:65], v77 offset:47104
    ds_read_b64_tr_b16 v[66:67], v77 offset:48128
    s_waitcnt lgkmcnt(0)
    s_barrier
    v_mfma_f32_32x32x16_bf16 v[4:19], v[56:59], v[40:43], v[4:19]
    ds_read_b128 v[36:39], v76 offset:49152
    ds_read_b64_tr_b16 v[52:53], v77 offset:57344
    ds_read_b64_tr_b16 v[54:55], v77 offset:58368
    s_waitcnt lgkmcnt(6)
    v_mfma_f32_32x32x16_bf16 v[4:19], v[60:63], v[44:47], v[4:19]
    ds_read_b128 v[40:43], v76 offset:51200
    ds_read_b64_tr_b16 v[56:57], v77 offset:59392
    ds_read_b64_tr_b16 v[58:59], v77 offset:60416
    s_waitcnt lgkmcnt(6)
    v_mfma_f32_32x32x16_bf16 v[4:19], v[64:67], v[48:51], v[4:19]
    ds_read_b128 v[44:47], v76 offset:53248
    ds_read_b64_tr_b16 v[60:61], v77 offset:61440
    ds_read_b64_tr_b16 v[62:63], v77 offset:62464
    s_waitcnt lgkmcnt(6)
    v_mfma_f32_32x32x16_bf16 v[4:19], v[52:55], v[36:39], v[4:19]
    ds_read_b128 v[48:51], v76 offset:55296
    ds_read_b64_tr_b16 v[64:65], v77 offset:63488
    ds_read_b64_tr_b16 v[66:67], v77 offset:64512
    s_waitcnt lgkmcnt(0)
    s_barrier
    v_mfma_f32_32x32x16_bf16 v[4:19], v[56:59], v[40:43], v[4:19]
    ds_read_b128 v[36:39], v76 offset:0
    ds_read_b64_tr_b16 v[52:53], v77 offset:8192
    ds_read_b64_tr_b16 v[54:55], v77 offset:9216
    s_waitcnt lgkmcnt(6)
    v_mfma_f32_32x32x16_bf16 v[4:19], v[60:63], v[44:47], v[4:19]
    ds_read_b128 v[40:43], v76 offset:2048
    ds_read_b64_tr_b16 v[56:57], v77 offset:10240
    ds_read_b64_tr_b16 v[58:59], v77 offset:11264
    s_waitcnt lgkmcnt(6)
    v_mfma_f32_32x32x16_bf16 v[4:19], v[64:67], v[48:51], v[4:19]
    ds_read_b128 v[44:47], v76 offset:4096
    ds_read_b64_tr_b16 v[60:61], v77 offset:12288
    ds_read_b64_tr_b16 v[62:63], v77 offset:13312
    s_waitcnt lgkmcnt(6)
    v_mfma_f32_32x32x16_bf16 v[4:19], v[52:55], v[36:39], v[4:19]
    ds_read_b128 v[48:51], v76 offset:6144
    ds_read_b64_tr_b16 v[64:65], v77 offset:14336
    ds_read_b64_tr_b16 v[66:67], v77 offset:15360
    s_waitcnt lgkmcnt(0)
    s_barrier
    v_mfma_f32_32x32x16_bf16 v[4:19], v[56:59], v[40:43], v[4:19]
    ds_read_b128 v[36:39], v76 offset:16384
    ds_read_b64_tr_b16 v[52:53], v77 offset:24576
    ds_read_b64_tr_b16 v[54:55], v77 offset:25600
    s_waitcnt lgkmcnt(6)
    v_mfma_f32_32x32x16_bf16 v[4:19], v[60:63], v[44:47], v[4:19]
    ds_read_b128 v[40:43], v76 offset:18432
    ds_read_b64_tr_b16 v[56:57], v77 offset:26624
    ds_read_b64_tr_b16 v[58:59], v77 offset:27648
    s_waitcnt lgkmcnt(6)
    v_mfma_f32_32x32x16_bf16 v[4:19], v[64:67], v[48:51], v[4:19]
    ds_read_b128 v[44:47], v76 offset:20480
    ds_read_b64_tr_b16 v[60:61], v77 offset:28672
    ds_read_b64_tr_b16 v[62:63], v77 offset:29696
    s_waitcnt lgkmcnt(6)
    v_mfma_f32_32x32x16_bf16 v[4:19], v[52:55], v[36:39], v[4:19]
    ds_read_b128 v[48:51], v76 offset:22528
    ds_read_b64_tr_b16 v[64:65], v77 offset:30720
    ds_read_b64_tr_b16 v[66:67], v77 offset:31744
    s_waitcnt lgkmcnt(0)
    s_barrier
    v_mfma_f32_32x32x16_bf16 v[4:19], v[56:59], v[40:43], v[4:19]
    ds_read_b128 v[36:39], v76 offset:32768
    ds_read_b64_tr_b16 v[52:53], v77 offset:40960
    ds_read_b64_tr_b16 v[54:55], v77 offset:41984
    s_waitcnt lgkmcnt(6)
    v_mfma_f32_32x32x16_bf16 v[4:19], v[60:63], v[44:47], v[4:19]
    ds_read_b128 v[40:43], v76 offset:34816
    ds_read_b64_tr_b16 v[56:57], v77 offset:43008
    ds_read_b64_tr_b16 v[58:59], v77 offset:44032
    s_waitcnt lgkmcnt(6)
    v_mfma_f32_32x32x16_bf16 v[4:19], v[64:67], v[48:51], v[4:19]
    ds_read_b128 v[44:47], v76 offset:36864
    ds_read_b64_tr_b16 v[60:61], v77 offset:45056
    ds_read_b64_tr_b16 v[62:63], v77 offset:46080
    s_waitcnt lgkmcnt(6)
    v_mfma_f32_32x32x16_bf16 v[4:19], v[52:55], v[36:39], v[4:19]
    ds_read_b128 v[48:51], v76 offset:38912
    ds_read_b64_tr_b16 v[64:65], v77 offset:47104
    ds_read_b64_tr_b16 v[66:67], v77 offset:48128
    s_waitcnt lgkmcnt(0)
    s_barrier
    v_mfma_f32_32x32x16_bf16 v[4:19], v[56:59], v[40:43], v[4:19]
    ds_read_b128 v[36:39], v76 offset:49152
    ds_read_b64_tr_b16 v[52:53], v77 offset:57344
    ds_read_b64_tr_b16 v[54:55], v77 offset:58368
    s_waitcnt lgkmcnt(6)
    v_mfma_f32_32x32x16_bf16 v[4:19], v[60:63], v[44:47], v[4:19]
    ds_read_b128 v[40:43], v76 offset:51200
    ds_read_b64_tr_b16 v[56:57], v77 offset:59392
    ds_read_b64_tr_b16 v[58:59], v77 offset:60416
    s_waitcnt lgkmcnt(6)
    v_mfma_f32_32x32x16_bf16 v[4:19], v[64:67], v[48:51], v[4:19]
    ds_read_b128 v[44:47], v76 offset:53248
    ds_read_b64_tr_b16 v[60:61], v77 offset:61440
    ds_read_b64_tr_b16 v[62:63], v77 offset:62464
    s_waitcnt lgkmcnt(6)
    v_mfma_f32_32x32x16_bf16 v[4:19], v[52:55], v[36:39], v[4:19]
    ds_read_b128 v[48:51], v76 offset:55296
    ds_read_b64_tr_b16 v[64:65], v77 offset:63488
    ds_read_b64_tr_b16 v[66:67], v77 offset:64512
    s_waitcnt lgkmcnt(0)
    s_barrier
    v_mfma_f32_32x32x16_bf16 v[4:19], v[56:59], v[40:43], v[4:19]
    ds_read_b128 v[36:39], v76 offset:0
    ds_read_b64_tr_b16 v[52:53], v77 offset:8192
    ds_read_b64_tr_b16 v[54:55], v77 offset:9216
    s_waitcnt lgkmcnt(6)
    v_mfma_f32_32x32x16_bf16 v[4:19], v[60:63], v[44:47], v[4:19]
    ds_read_b128 v[40:43], v76 offset:2048
    ds_read_b64_tr_b16 v[56:57], v77 offset:10240
    ds_read_b64_tr_b16 v[58:59], v77 offset:11264
    s_waitcnt lgkmcnt(6)
    v_mfma_f32_32x32x16_bf16 v[4:19], v[64:67], v[48:51], v[4:19]
    ds_read_b128 v[44:47], v76 offset:4096
    ds_read_b64_tr_b16 v[60:61], v77 offset:12288
    ds_read_b64_tr_b16 v[62:63], v77 offset:13312
    s_waitcnt lgkmcnt(6)
    v_mfma_f32_32x32x16_bf16 v[4:19], v[52:55], v[36:39], v[4:19]
    ds_read_b128 v[48:51], v76 offset:6144
    ds_read_b64_tr_b16 v[64:65], v77 offset:14336
    ds_read_b64_tr_b16 v[66:67], v77 offset:15360
    s_waitcnt vmcnt(0)
    v_add_f32 v100, v100, v101
    v_add_f32 v100, v100, v102
    v_add_f32 v100, v100, v103
    v_add_f32 v100, v100, v104
    v_add_f32 v100, v100, v105
    v_add_f32 v100, v100, v106
    v_add_f32 v100, v100, v107
    v_mov_b32 v89, v100
    s_nop 1
    v_permlane32_swap_b32 v89, v100
    s_nop 1
    v_add_f32 v89, v89, v100
    v_mul_f32 v89, 0xbfb8aa3b, v89
    v_exp_f32 v89, v89
    s_nop 0
    v_add_f32 v89, 1.0, v89
    v_rcp_f32 v89, v89
    s_nop 0
    v_sub_f32 v90, 1.0, v89
    s_waitcnt lgkmcnt(0)
    s_barrier
    v_mfma_f32_32x32x16_bf16 v[4:19], v[56:59], v[40:43], v[4:19]
    ds_read_b128 v[36:39], v76 offset:16384
    ds_read_b64_tr_b16 v[52:53], v77 offset:24576
    ds_read_b64_tr_b16 v[54:55], v77 offset:25600
    s_waitcnt lgkmcnt(6)
    v_mfma_f32_32x32x16_bf16 v[4:19], v[60:63], v[44:47], v[4:19]
    ds_read_b128 v[40:43], v76 offset:18432
    ds_read_b64_tr_b16 v[56:57], v77 offset:26624
    ds_read_b64_tr_b16 v[58:59], v77 offset:27648
    s_waitcnt lgkmcnt(6)
    v_mfma_f32_32x32x16_bf16 v[4:19], v[64:67], v[48:51], v[4:19]
    ds_read_b128 v[44:47], v76 offset:20480
    ds_read_b64_tr_b16 v[60:61], v77 offset:28672
    ds_read_b64_tr_b16 v[62:63], v77 offset:29696
    s_waitcnt lgkmcnt(6)
    v_mfma_f32_32x32x16_bf16 v[4:19], v[52:55], v[36:39], v[4:19]
    ds_read_b128 v[48:51], v76 offset:22528
    ds_read_b64_tr_b16 v[64:65], v77 offset:30720
    ds_read_b64_tr_b16 v[66:67], v77 offset:31744
    s_waitcnt lgkmcnt(0)
    s_barrier
    v_mfma_f32_32x32x16_bf16 v[4:19], v[56:59], v[40:43], v[4:19]
    ds_read_b128 v[36:39], v76 offset:32768
    ds_read_b64_tr_b16 v[52:53], v77 offset:40960
    ds_read_b64_tr_b16 v[54:55], v77 offset:41984
    s_waitcnt lgkmcnt(6)
    v_mfma_f32_32x32x16_bf16 v[4:19], v[60:63], v[44:47], v[4:19]
    ds_read_b128 v[40:43], v76 offset:34816
    ds_read_b64_tr_b16 v[56:57], v77 offset:43008
    ds_read_b64_tr_b16 v[58:59], v77 offset:44032
    s_waitcnt lgkmcnt(6)
    v_mfma_f32_32x32x16_bf16 v[4:19], v[64:67], v[48:51], v[4:19]
    ds_read_b128 v[44:47], v76 offset:36864
    ds_read_b64_tr_b16 v[60:61], v77 offset:45056
    ds_read_b64_tr_b16 v[62:63], v77 offset:46080
    s_waitcnt lgkmcnt(6)
    v_mfma_f32_32x32x16_bf16 v[4:19], v[52:55], v[36:39], v[4:19]
    ds_read_b128 v[48:51], v76 offset:38912
    ds_read_b64_tr_b16 v[64:65], v77 offset:47104
    ds_read_b64_tr_b16 v[66:67], v77 offset:48128
    s_waitcnt lgkmcnt(0)
    s_barrier
    v_mfma_f32_32x32x16_bf16 v[4:19], v[56:59], v[40:43], v[4:19]
    ds_read_b128 v[36:39], v76 offset:49152
    ds_read_b64_tr_b16 v[52:53], v77 offset:57344
    ds_read_b64_tr_b16 v[54:55], v77 offset:58368
    s_waitcnt lgkmcnt(6)
    v_mfma_f32_32x32x16_bf16 v[4:19], v[60:63], v[44:47], v[4:19]
    ds_read_b128 v[40:43], v76 offset:51200
    ds_read_b64_tr_b16 v[56:57], v77 offset:59392
    ds_read_b64_tr_b16 v[58:59], v77 offset:60416
    s_waitcnt lgkmcnt(6)
    v_mfma_f32_32x32x16_bf16 v[4:19], v[64:67], v[48:51], v[4:19]
    ds_read_b128 v[44:47], v76 offset:53248
    ds_read_b64_tr_b16 v[60:61], v77 offset:61440
    ds_read_b64_tr_b16 v[62:63], v77 offset:62464
    s_waitcnt lgkmcnt(6)
    v_mfma_f32_32x32x16_bf16 v[4:19], v[52:55], v[36:39], v[4:19]
    ds_read_b128 v[48:51], v76 offset:55296
    ds_read_b64_tr_b16 v[64:65], v77 offset:63488
    ds_read_b64_tr_b16 v[66:67], v77 offset:64512
    s_waitcnt lgkmcnt(0)
    s_barrier
    v_mfma_f32_32x32x16_bf16 v[4:19], v[56:59], v[40:43], v[4:19]
    ds_read_b128 v[36:39], v76 offset:0
    ds_read_b64_tr_b16 v[52:53], v77 offset:8192
    ds_read_b64_tr_b16 v[54:55], v77 offset:9216
    s_waitcnt lgkmcnt(6)
    v_mfma_f32_32x32x16_bf16 v[4:19], v[60:63], v[44:47], v[4:19]
    ds_read_b128 v[40:43], v76 offset:2048
    ds_read_b64_tr_b16 v[56:57], v77 offset:10240
    ds_read_b64_tr_b16 v[58:59], v77 offset:11264
    s_waitcnt lgkmcnt(6)
    v_mfma_f32_32x32x16_bf16 v[4:19], v[64:67], v[48:51], v[4:19]
    ds_read_b128 v[44:47], v76 offset:4096
    ds_read_b64_tr_b16 v[60:61], v77 offset:12288
    ds_read_b64_tr_b16 v[62:63], v77 offset:13312
    s_waitcnt lgkmcnt(6)
    v_mfma_f32_32x32x16_bf16 v[4:19], v[52:55], v[36:39], v[4:19]
    ds_read_b128 v[48:51], v76 offset:6144
    ds_read_b64_tr_b16 v[64:65], v77 offset:14336
    ds_read_b64_tr_b16 v[66:67], v77 offset:15360
    s_waitcnt lgkmcnt(0)
    s_barrier
    v_mfma_f32_32x32x16_bf16 v[4:19], v[56:59], v[40:43], v[4:19]
    ds_read_b128 v[36:39], v76 offset:16384
    ds_read_b64_tr_b16 v[52:53], v77 offset:24576
    ds_read_b64_tr_b16 v[54:55], v77 offset:25600
    s_waitcnt lgkmcnt(6)
    v_mfma_f32_32x32x16_bf16 v[4:19], v[60:63], v[44:47], v[4:19]
    ds_read_b128 v[40:43], v76 offset:18432
    ds_read_b64_tr_b16 v[56:57], v77 offset:26624
    ds_read_b64_tr_b16 v[58:59], v77 offset:27648
    s_waitcnt lgkmcnt(6)
    v_mfma_f32_32x32x16_bf16 v[4:19], v[64:67], v[48:51], v[4:19]
    ds_read_b128 v[44:47], v76 offset:20480
    ds_read_b64_tr_b16 v[60:61], v77 offset:28672
    ds_read_b64_tr_b16 v[62:63], v77 offset:29696
    s_waitcnt lgkmcnt(6)
    v_mfma_f32_32x32x16_bf16 v[4:19], v[52:55], v[36:39], v[4:19]
    ds_read_b128 v[48:51], v76 offset:22528
    ds_read_b64_tr_b16 v[64:65], v77 offset:30720
    ds_read_b64_tr_b16 v[66:67], v77 offset:31744
    s_waitcnt lgkmcnt(0)
    s_barrier
    v_mfma_f32_32x32x16_bf16 v[4:19], v[56:59], v[40:43], v[4:19]
    ds_read_b128 v[36:39], v76 offset:32768
    ds_read_b64_tr_b16 v[52:53], v77 offset:40960
    ds_read_b64_tr_b16 v[54:55], v77 offset:41984
    s_waitcnt lgkmcnt(6)
    v_mfma_f32_32x32x16_bf16 v[4:19], v[60:63], v[44:47], v[4:19]
    ds_read_b128 v[40:43], v76 offset:34816
    ds_read_b64_tr_b16 v[56:57], v77 offset:43008
    ds_read_b64_tr_b16 v[58:59], v77 offset:44032
    s_waitcnt lgkmcnt(6)
    v_mfma_f32_32x32x16_bf16 v[4:19], v[64:67], v[48:51], v[4:19]
    ds_read_b128 v[44:47], v76 offset:36864
    ds_read_b64_tr_b16 v[60:61], v77 offset:45056
    ds_read_b64_tr_b16 v[62:63], v77 offset:46080
    s_waitcnt lgkmcnt(6)
    v_mfma_f32_32x32x16_bf16 v[4:19], v[52:55], v[36:39], v[4:19]
    ds_read_b128 v[48:51], v76 offset:38912
    ds_read_b64_tr_b16 v[64:65], v77 offset:47104
    ds_read_b64_tr_b16 v[66:67], v77 offset:48128
    s_waitcnt lgkmcnt(0)
    s_barrier
    v_mfma_f32_32x32x16_bf16 v[4:19], v[56:59], v[40:43], v[4:19]
    ds_read_b128 v[36:39], v76 offset:49152
    ds_read_b64_tr_b16 v[52:53], v77 offset:57344
    ds_read_b64_tr_b16 v[54:55], v77 offset:58368
    s_waitcnt lgkmcnt(6)
    v_mfma_f32_32x32x16_bf16 v[4:19], v[60:63], v[44:47], v[4:19]
    ds_read_b128 v[40:43], v76 offset:51200
    ds_read_b64_tr_b16 v[56:57], v77 offset:59392
    ds_read_b64_tr_b16 v[58:59], v77 offset:60416
    s_waitcnt lgkmcnt(6)
    v_mfma_f32_32x32x16_bf16 v[4:19], v[64:67], v[48:51], v[4:19]
    ds_read_b128 v[44:47], v76 offset:53248
    ds_read_b64_tr_b16 v[60:61], v77 offset:61440
    ds_read_b64_tr_b16 v[62:63], v77 offset:62464
    s_waitcnt lgkmcnt(6)
    v_mfma_f32_32x32x16_bf16 v[4:19], v[52:55], v[36:39], v[4:19]
    ds_read_b128 v[48:51], v76 offset:55296
    ds_read_b64_tr_b16 v[64:65], v77 offset:63488
    ds_read_b64_tr_b16 v[66:67], v77 offset:64512
    s_waitcnt lgkmcnt(0)
    s_barrier
    v_mfma_f32_32x32x16_bf16 v[4:19], v[56:59], v[40:43], v[4:19]
    ds_read_b128 v[36:39], v76 offset:0
    ds_read_b64_tr_b16 v[52:53], v77 offset:8192
    ds_read_b64_tr_b16 v[54:55], v77 offset:9216
    s_waitcnt lgkmcnt(6)
    v_mfma_f32_32x32x16_bf16 v[4:19], v[60:63], v[44:47], v[4:19]
    ds_read_b128 v[40:43], v76 offset:2048
    ds_read_b64_tr_b16 v[56:57], v77 offset:10240
    ds_read_b64_tr_b16 v[58:59], v77 offset:11264
    s_waitcnt lgkmcnt(6)
    v_mfma_f32_32x32x16_bf16 v[4:19], v[64:67], v[48:51], v[4:19]
    ds_read_b128 v[44:47], v76 offset:4096
    ds_read_b64_tr_b16 v[60:61], v77 offset:12288
    ds_read_b64_tr_b16 v[62:63], v77 offset:13312
    s_waitcnt lgkmcnt(6)
    v_mfma_f32_32x32x16_bf16 v[4:19], v[52:55], v[36:39], v[4:19]
    ds_read_b128 v[48:51], v76 offset:6144
    ds_read_b64_tr_b16 v[64:65], v77 offset:14336
    ds_read_b64_tr_b16 v[66:67], v77 offset:15360
    s_waitcnt lgkmcnt(0)
    s_barrier
    v_mfma_f32_32x32x16_bf16 v[4:19], v[56:59], v[40:43], v[4:19]
    ds_read_b128 v[36:39], v76 offset:16384
    ds_read_b64_tr_b16 v[52:53], v77 offset:24576
    ds_read_b64_tr_b16 v[54:55], v77 offset:25600
    s_waitcnt lgkmcnt(6)
    v_mfma_f32_32x32x16_bf16 v[4:19], v[60:63], v[44:47], v[4:19]
    ds_read_b128 v[40:43], v76 offset:18432
    ds_read_b64_tr_b16 v[56:57], v77 offset:26624
    ds_read_b64_tr_b16 v[58:59], v77 offset:27648
    s_waitcnt lgkmcnt(6)
    v_mfma_f32_32x32x16_bf16 v[4:19], v[64:67], v[48:51], v[4:19]
    ds_read_b128 v[44:47], v76 offset:20480
    ds_read_b64_tr_b16 v[60:61], v77 offset:28672
    ds_read_b64_tr_b16 v[62:63], v77 offset:29696
    s_waitcnt lgkmcnt(6)
    v_mfma_f32_32x32x16_bf16 v[4:19], v[52:55], v[36:39], v[4:19]
    ds_read_b128 v[48:51], v76 offset:22528
    ds_read_b64_tr_b16 v[64:65], v77 offset:30720
    ds_read_b64_tr_b16 v[66:67], v77 offset:31744
    s_waitcnt lgkmcnt(0)
    s_barrier
    v_mfma_f32_32x32x16_bf16 v[4:19], v[56:59], v[40:43], v[4:19]
    ds_read_b128 v[36:39], v76 offset:32768
    ds_read_b64_tr_b16 v[52:53], v77 offset:40960
    ds_read_b64_tr_b16 v[54:55], v77 offset:41984
    s_waitcnt lgkmcnt(6)
    v_mfma_f32_32x32x16_bf16 v[4:19], v[60:63], v[44:47], v[4:19]
    ds_read_b128 v[40:43], v76 offset:34816
    ds_read_b64_tr_b16 v[56:57], v77 offset:43008
    ds_read_b64_tr_b16 v[58:59], v77 offset:44032
    s_waitcnt lgkmcnt(6)
    v_mfma_f32_32x32x16_bf16 v[4:19], v[64:67], v[48:51], v[4:19]
    ds_read_b128 v[44:47], v76 offset:36864
    ds_read_b64_tr_b16 v[60:61], v77 offset:45056
    ds_read_b64_tr_b16 v[62:63], v77 offset:46080
    s_waitcnt lgkmcnt(6)
    v_mfma_f32_32x32x16_bf16 v[4:19], v[52:55], v[36:39], v[4:19]
    ds_read_b128 v[48:51], v76 offset:38912
    ds_read_b64_tr_b16 v[64:65], v77 offset:47104
    ds_read_b64_tr_b16 v[66:67], v77 offset:48128
    s_waitcnt lgkmcnt(0)
    s_barrier
    v_mfma_f32_32x32x16_bf16 v[4:19], v[56:59], v[40:43], v[4:19]
    ds_read_b128 v[36:39], v76 offset:49152
    ds_read_b64_tr_b16 v[52:53], v77 offset:57344
    ds_read_b64_tr_b16 v[54:55], v77 offset:58368
    s_waitcnt lgkmcnt(6)
    v_mfma_f32_32x32x16_bf16 v[4:19], v[60:63], v[44:47], v[4:19]
    ds_read_b128 v[40:43], v76 offset:51200
    ds_read_b64_tr_b16 v[56:57], v77 offset:59392
    ds_read_b64_tr_b16 v[58:59], v77 offset:60416
    s_waitcnt lgkmcnt(6)
    v_mfma_f32_32x32x16_bf16 v[4:19], v[64:67], v[48:51], v[4:19]
    ds_read_b128 v[44:47], v76 offset:53248
    ds_read_b64_tr_b16 v[60:61], v77 offset:61440
    ds_read_b64_tr_b16 v[62:63], v77 offset:62464
    s_waitcnt lgkmcnt(6)
    v_mfma_f32_32x32x16_bf16 v[4:19], v[52:55], v[36:39], v[4:19]
    ds_read_b128 v[48:51], v76 offset:55296
    ds_read_b64_tr_b16 v[64:65], v77 offset:63488
    ds_read_b64_tr_b16 v[66:67], v77 offset:64512
    s_waitcnt lgkmcnt(0)
    s_barrier
    v_mfma_f32_32x32x16_bf16 v[4:19], v[56:59], v[40:43], v[4:19]
    ds_read_b128 v[36:39], v76 offset:0
    ds_read_b64_tr_b16 v[52:53], v77 offset:8192
    ds_read_b64_tr_b16 v[54:55], v77 offset:9216
    s_waitcnt lgkmcnt(6)
    v_mfma_f32_32x32x16_bf16 v[4:19], v[60:63], v[44:47], v[4:19]
    ds_read_b128 v[40:43], v76 offset:2048
    ds_read_b64_tr_b16 v[56:57], v77 offset:10240
    ds_read_b64_tr_b16 v[58:59], v77 offset:11264
    s_waitcnt lgkmcnt(6)
    v_mfma_f32_32x32x16_bf16 v[4:19], v[64:67], v[48:51], v[4:19]
    ds_read_b128 v[44:47], v76 offset:4096
    ds_read_b64_tr_b16 v[60:61], v77 offset:12288
    ds_read_b64_tr_b16 v[62:63], v77 offset:13312
    s_waitcnt lgkmcnt(6)
    v_mfma_f32_32x32x16_bf16 v[4:19], v[52:55], v[36:39], v[4:19]
    ds_read_b128 v[48:51], v76 offset:6144
    ds_read_b64_tr_b16 v[64:65], v77 offset:14336
    ds_read_b64_tr_b16 v[66:67], v77 offset:15360
    s_waitcnt lgkmcnt(0)
    s_barrier
    v_mfma_f32_32x32x16_bf16 v[4:19], v[56:59], v[40:43], v[4:19]
    ds_read_b128 v[36:39], v76 offset:16384
    ds_read_b64_tr_b16 v[52:53], v77 offset:24576
    ds_read_b64_tr_b16 v[54:55], v77 offset:25600
    s_waitcnt lgkmcnt(6)
    v_mfma_f32_32x32x16_bf16 v[4:19], v[60:63], v[44:47], v[4:19]
    ds_read_b128 v[40:43], v76 offset:18432
    ds_read_b64_tr_b16 v[56:57], v77 offset:26624
    ds_read_b64_tr_b16 v[58:59], v77 offset:27648
    s_waitcnt lgkmcnt(6)
    v_mfma_f32_32x32x16_bf16 v[4:19], v[64:67], v[48:51], v[4:19]
    ds_read_b128 v[44:47], v76 offset:20480
    ds_read_b64_tr_b16 v[60:61], v77 offset:28672
    ds_read_b64_tr_b16 v[62:63], v77 offset:29696
    s_waitcnt lgkmcnt(6)
    v_mfma_f32_32x32x16_bf16 v[4:19], v[52:55], v[36:39], v[4:19]
    ds_read_b128 v[48:51], v76 offset:22528
    ds_read_b64_tr_b16 v[64:65], v77 offset:30720
    ds_read_b64_tr_b16 v[66:67], v77 offset:31744
    s_waitcnt lgkmcnt(0)
    s_barrier
    v_mfma_f32_32x32x16_bf16 v[4:19], v[56:59], v[40:43], v[4:19]
    ds_read_b128 v[36:39], v76 offset:32768
    ds_read_b64_tr_b16 v[52:53], v77 offset:40960
    ds_read_b64_tr_b16 v[54:55], v77 offset:41984
    s_waitcnt lgkmcnt(6)
    v_mfma_f32_32x32x16_bf16 v[4:19], v[60:63], v[44:47], v[4:19]
    ds_read_b128 v[40:43], v76 offset:34816
    ds_read_b64_tr_b16 v[56:57], v77 offset:43008
    ds_read_b64_tr_b16 v[58:59], v77 offset:44032
    s_waitcnt lgkmcnt(6)
    v_mfma_f32_32x32x16_bf16 v[4:19], v[64:67], v[48:51], v[4:19]
    ds_read_b128 v[44:47], v76 offset:36864
    ds_read_b64_tr_b16 v[60:61], v77 offset:45056
    ds_read_b64_tr_b16 v[62:63], v77 offset:46080
    s_waitcnt lgkmcnt(6)
    v_mfma_f32_32x32x16_bf16 v[4:19], v[52:55], v[36:39], v[4:19]
    ds_read_b128 v[48:51], v76 offset:38912
    ds_read_b64_tr_b16 v[64:65], v77 offset:47104
    ds_read_b64_tr_b16 v[66:67], v77 offset:48128
    s_waitcnt lgkmcnt(0)
    s_barrier
    v_mfma_f32_32x32x16_bf16 v[4:19], v[56:59], v[40:43], v[4:19]
    ds_read_b128 v[36:39], v76 offset:49152
    ds_read_b64_tr_b16 v[52:53], v77 offset:57344
    ds_read_b64_tr_b16 v[54:55], v77 offset:58368
    s_waitcnt lgkmcnt(6)
    v_mfma_f32_32x32x16_bf16 v[4:19], v[60:63], v[44:47], v[4:19]
    ds_read_b128 v[40:43], v76 offset:51200
    ds_read_b64_tr_b16 v[56:57], v77 offset:59392
    ds_read_b64_tr_b16 v[58:59], v77 offset:60416
    s_waitcnt lgkmcnt(6)
    v_mfma_f32_32x32x16_bf16 v[4:19], v[64:67], v[48:51], v[4:19]
    ds_read_b128 v[44:47], v76 offset:53248
    ds_read_b64_tr_b16 v[60:61], v77 offset:61440
    ds_read_b64_tr_b16 v[62:63], v77 offset:62464
    s_waitcnt lgkmcnt(6)
    v_mfma_f32_32x32x16_bf16 v[4:19], v[52:55], v[36:39], v[4:19]
    ds_read_b128 v[48:51], v76 offset:55296
    ds_read_b64_tr_b16 v[64:65], v77 offset:63488
    ds_read_b64_tr_b16 v[66:67], v77 offset:64512
    s_waitcnt lgkmcnt(6)
    v_mfma_f32_32x32x16_bf16 v[4:19], v[56:59], v[40:43], v[4:19]
    s_waitcnt lgkmcnt(3)
    v_mfma_f32_32x32x16_bf16 v[4:19], v[60:63], v[44:47], v[4:19]
    s_waitcnt lgkmcnt(0)
    v_mfma_f32_32x32x16_bf16 v[4:19], v[64:67], v[48:51], v[4:19]
    s_barrier
    s_setprio 3
    s_lshl_b32 s39, s70, 1
    s_add_u32 s39, s39, s37
    s_lshl_b32 s39, s39, 10
    s_nop 5
    v_lshlrev_b32 v87, 16, v92
    v_and_b32 v88, 0xffff0000, v92
    v_add_f32 v4, v4, v87
    v_add_f32 v5, v5, v88
    v_mul_f32 v4, v4, v90
    v_mul_f32 v5, v5, v90
    v_lshlrev_b32 v87, 16, v93
    v_and_b32 v88, 0xffff0000, v93
    v_add_f32 v6, v6, v87
    v_add_f32 v7, v7, v88
    v_mul_f32 v6, v6, v90
    v_mul_f32 v7, v7, v90
    v_lshlrev_b32 v87, 16, v94
    v_and_b32 v88, 0xffff0000, v94
    v_add_f32 v8, v8, v87
    v_add_f32 v9, v9, v88
    v_mul_f32 v8, v8, v90
    v_mul_f32 v9, v9, v90
    v_lshlrev_b32 v87, 16, v95
    v_and_b32 v88, 0xffff0000, v95
    v_add_f32 v10, v10, v87
    v_add_f32 v11, v11, v88
    v_mul_f32 v10, v10, v90
    v_mul_f32 v11, v11, v90
    v_lshlrev_b32 v87, 16, v96
    v_and_b32 v88, 0xffff0000, v96
    v_add_f32 v12, v12, v87
    v_add_f32 v13, v13, v88
    v_mul_f32 v12, v12, v90
    v_mul_f32 v13, v13, v90
    v_lshlrev_b32 v87, 16, v97
    v_and_b32 v88, 0xffff0000, v97
    v_add_f32 v14, v14, v87
    v_add_f32 v15, v15, v88
    v_mul_f32 v14, v14, v90
    v_mul_f32 v15, v15, v90
    v_lshlrev_b32 v87, 16, v98
    v_and_b32 v88, 0xffff0000, v98
    v_add_f32 v16, v16, v87
    v_add_f32 v17, v17, v88
    v_mul_f32 v16, v16, v90
    v_mul_f32 v17, v17, v90
    v_lshlrev_b32 v87, 16, v99
    v_and_b32 v88, 0xffff0000, v99
    v_add_f32 v18, v18, v87
    v_add_f32 v19, v19, v88
    v_mul_f32 v18, v18, v90
    v_mul_f32 v19, v19, v90
    s_barrier
    buffer_load_dwordx4 v[36:39], v84, s[20:23], s39 offen sc1
    s_add_u32 s39, s39, 0x10000
    buffer_load_dwordx4 v[40:43], v84, s[20:23], s39 offen sc1
    s_add_u32 s39, s39, 0x10000
    buffer_load_dwordx4 v[44:47], v84, s[20:23], s39 offen sc1
    s_add_u32 s39, s39, 0x10000
    buffer_load_dwordx4 v[48:51], v84, s[20:23], s39 offen sc1
    s_add_u32 s39, s39, 0x10000
    buffer_load_dwordx4 v[92:95], v84, s[20:23], s39 offen sc1
    s_add_u32 s39, s39, 0x10000
    buffer_load_dwordx4 v[96:99], v84, s[20:23], s39 offen sc1
    s_add_u32 s39, s39, 0x10000
    buffer_load_dwordx4 v[100:103], v84, s[20:23], s39 offen sc1
    s_add_u32 s39, s39, 0x10000
    buffer_load_dwordx4 v[104:107], v84, s[20:23], s39 offen sc1
    s_add_u32 s39, s39, 0x10000
    buffer_load_dwordx4 v[116:119], v84, s[20:23], s39 offen sc1
    s_add_u32 s39, s39, 0x10000
    buffer_load_dwordx4 v[120:123], v84, s[20:23], s39 offen sc1
    s_add_u32 s39, s39, 0x10000
    buffer_load_dwordx4 v[124:127], v84, s[20:23], s39 offen sc1
    s_add_u32 s39, s39, 0x10000
    ds_read_b64_tr_b16 v[52:53], v77 offset:0
    ds_read_b64_tr_b16 v[54:55], v77 offset:1024
    ds_read_b64_tr_b16 v[56:57], v77 offset:2048
    ds_read_b64_tr_b16 v[58:59], v77 offset:3072
    ds_read_b64_tr_b16 v[60:61], v77 offset:4096
    ds_read_b64_tr_b16 v[62:63], v77 offset:5120
    s_waitcnt vmcnt(10) lgkmcnt(4)
    v_mfma_f32_32x32x16_bf16 v[20:35], v[52:55], v[36:39], 0
    ds_read_b64_tr_b16 v[64:65], v77 offset:6144
    ds_read_b64_tr_b16 v[66:67], v77 offset:7168
    buffer_load_dwordx4 v[36:39], v84, s[20:23], s39 offen sc1
    s_add_u32 s39, s39, 0x10000
    s_waitcnt vmcnt(10) lgkmcnt(4)
    v_mfma_f32_32x32x16_bf16 v[20:35], v[56:59], v[40:43], v[20:35]
    ds_read_b64_tr_b16 v[52:53], v77 offset:8192
    ds_read_b64_tr_b16 v[54:55], v77 offset:9216
    buffer_load_dwordx4 v[40:43], v84, s[20:23], s39 offen sc1
    s_add_u32 s39, s39, 0x10000
    s_waitcnt vmcnt(10) lgkmcnt(4)
    v_mfma_f32_32x32x16_bf16 v[20:35], v[60:63], v[44:47], v[20:35]
    ds_read_b64_tr_b16 v[56:57], v77 offset:10240
    ds_read_b64_tr_b16 v[58:59], v77 offset:11264
    buffer_load_dwordx4 v[44:47], v84, s[20:23], s39 offen sc1
    s_add_u32 s39, s39, 0x10000
    s_waitcnt vmcnt(10) lgkmcnt(4)
    v_mfma_f32_32x32x16_bf16 v[20:35], v[64:67], v[48:51], v[20:35]
    ds_read_b64_tr_b16 v[60:61], v77 offset:12288
    ds_read_b64_tr_b16 v[62:63], v77 offset:13312
    buffer_load_dwordx4 v[48:51], v84, s[20:23], s39 offen sc1
    s_add_u32 s39, s39, 0x10000
    s_waitcnt vmcnt(10) lgkmcnt(4)
    v_mfma_f32_32x32x16_bf16 v[20:35], v[52:55], v[92:95], v[20:35]
    ds_read_b64_tr_b16 v[64:65], v77 offset:14336
    ds_read_b64_tr_b16 v[66:67], v77 offset:15360
    buffer_load_dwordx4 v[92:95], v84, s[20:23], s39 offen sc1
    s_add_u32 s39, s39, 0x10000
    s_waitcnt vmcnt(10) lgkmcnt(4)
    v_mfma_f32_32x32x16_bf16 v[20:35], v[56:59], v[96:99], v[20:35]
    ds_read_b64_tr_b16 v[52:53], v77 offset:16384
    ds_read_b64_tr_b16 v[54:55], v77 offset:17408
    buffer_load_dwordx4 v[96:99], v84, s[20:23], s39 offen sc1
    s_add_u32 s39, s39, 0x10000
    s_waitcnt vmcnt(10) lgkmcnt(4)
    v_mfma_f32_32x32x16_bf16 v[20:35], v[60:63], v[100:103], v[20:35]
    ds_read_b64_tr_b16 v[56:57], v77 offset:18432
    ds_read_b64_tr_b16 v[58:59], v77 offset:19456
    buffer_load_dwordx4 v[100:103], v84, s[20:23], s39 offen sc1
    s_add_u32 s39, s39, 0x10000
    s_waitcnt vmcnt(10) lgkmcnt(4)
    v_mfma_f32_32x32x16_bf16 v[20:35], v[64:67], v[104:107], v[20:35]
    ds_read_b64_tr_b16 v[60:61], v77 offset:20480
    ds_read_b64_tr_b16 v[62:63], v77 offset:21504
    buffer_load_dwordx4 v[104:107], v84, s[20:23], s39 offen sc1
    s_add_u32 s39, s39, 0x10000
    s_waitcnt vmcnt(10) lgkmcnt(4)
    v_mfma_f32_32x32x16_bf16 v[20:35], v[52:55], v[116:119], v[20:35]
    ds_read_b64_tr_b16 v[64:65], v77 offset:22528
    ds_read_b64_tr_b16 v[66:67], v77 offset:23552
    buffer_load_dwordx4 v[116:119], v84, s[20:23], s39 offen sc1
    s_add_u32 s39, s39, 0x10000
    s_waitcnt vmcnt(10) lgkmcnt(4)
    v_mfma_f32_32x32x16_bf16 v[20:35], v[56:59], v[120:123], v[20:35]
    ds_read_b64_tr_b16 v[52:53], v77 offset:24576
    ds_read_b64_tr_b16 v[54:55], v77 offset:25600
    buffer_load_dwordx4 v[120:123], v84, s[20:23], s39 offen sc1
    s_add_u32 s39, s39, 0x10000
    s_waitcnt vmcnt(10) lgkmcnt(4)
    v_mfma_f32_32x32x16_bf16 v[20:35], v[60:63], v[124:127], v[20:35]
    ds_read_b64_tr_b16 v[56:57], v77 offset:26624
    ds_read_b64_tr_b16 v[58:59], v77 offset:27648
    buffer_load_dwordx4 v[124:127], v84, s[20:23], s39 offen sc1
    s_add_u32 s39, s39, 0x10000
    s_waitcnt vmcnt(10) lgkmcnt(4)
    v_mfma_f32_32x32x16_bf16 v[20:35], v[64:67], v[36:39], v[20:35]
    ds_read_b64_tr_b16 v[60:61], v77 offset:28672
    ds_read_b64_tr_b16 v[62:63], v77 offset:29696
    buffer_load_dwordx4 v[36:39], v84, s[20:23], s39 offen sc1
    s_add_u32 s39, s39, 0x10000
    s_waitcnt vmcnt(10) lgkmcnt(4)
    v_mfma_f32_32x32x16_bf16 v[20:35], v[52:55], v[40:43], v[20:35]
    ds_read_b64_tr_b16 v[64:65], v77 offset:30720
    ds_read_b64_tr_b16 v[66:67], v77 offset:31744
    buffer_load_dwordx4 v[40:43], v84, s[20:23], s39 offen sc1
    s_add_u32 s39, s39, 0x10000
    s_waitcnt vmcnt(10) lgkmcnt(4)
    v_mfma_f32_32x32x16_bf16 v[20:35], v[56:59], v[44:47], v[20:35]
    ds_read_b64_tr_b16 v[52:53], v77 offset:32768
    ds_read_b64_tr_b16 v[54:55], v77 offset:33792
    buffer_load_dwordx4 v[44:47], v84, s[20:23], s39 offen sc1
    s_add_u32 s39, s39, 0x10000
    s_waitcnt vmcnt(10) lgkmcnt(4)
    v_mfma_f32_32x32x16_bf16 v[20:35], v[60:63], v[48:51], v[20:35]
    ds_read_b64_tr_b16 v[56:57], v77 offset:34816
    ds_read_b64_tr_b16 v[58:59], v77 offset:35840
    buffer_load_dwordx4 v[48:51], v84, s[20:23], s39 offen sc1
    s_add_u32 s39, s39, 0x10000
    s_waitcnt vmcnt(10) lgkmcnt(4)
    v_mfma_f32_32x32x16_bf16 v[20:35], v[64:67], v[92:95], v[20:35]
    ds_read_b64_tr_b16 v[60:61], v77 offset:36864
    ds_read_b64_tr_b16 v[62:63], v77 offset:37888
    buffer_load_dwordx4 v[92:95], v84, s[20:23], s39 offen sc1
    s_add_u32 s39, s39, 0x10000
    s_waitcnt vmcnt(10) lgkmcnt(4)
    v_mfma_f32_32x32x16_bf16 v[20:35], v[52:55], v[96:99], v[20:35]
    ds_read_b64_tr_b16 v[64:65], v77 offset:38912
    ds_read_b64_tr_b16 v[66:67], v77 offset:39936
    buffer_load_dwordx4 v[96:99], v84, s[20:23], s39 offen sc1
    s_add_u32 s39, s39, 0x10000
    s_waitcnt vmcnt(10) lgkmcnt(4)
    v_mfma_f32_32x32x16_bf16 v[20:35], v[56:59], v[100:103], v[20:35]
    ds_read_b64_tr_b16 v[52:53], v77 offset:40960
    ds_read_b64_tr_b16 v[54:55], v77 offset:41984
    buffer_load_dwordx4 v[100:103], v84, s[20:23], s39 offen sc1
    s_add_u32 s39, s39, 0x10000
    s_waitcnt vmcnt(10) lgkmcnt(4)
    v_mfma_f32_32x32x16_bf16 v[20:35], v[60:63], v[104:107], v[20:35]
    ds_read_b64_tr_b16 v[56:57], v77 offset:43008
    ds_read_b64_tr_b16 v[58:59], v77 offset:44032
    buffer_load_dwordx4 v[104:107], v84, s[20:23], s39 offen sc1
    s_add_u32 s39, s39, 0x10000
    s_waitcnt vmcnt(10) lgkmcnt(4)
    v_mfma_f32_32x32x16_bf16 v[20:35], v[64:67], v[116:119], v[20:35]
    ds_read_b64_tr_b16 v[60:61], v77 offset:45056
    ds_read_b64_tr_b16 v[62:63], v77 offset:46080
    buffer_load_dwordx4 v[116:119], v84, s[20:23], s39 offen sc1
    s_add_u32 s39, s39, 0x10000
    s_waitcnt vmcnt(10) lgkmcnt(4)
    v_mfma_f32_32x32x16_bf16 v[20:35], v[52:55], v[120:123], v[20:35]
    ds_read_b64_tr_b16 v[64:65], v77 offset:47104
    ds_read_b64_tr_b16 v[66:67], v77 offset:48128
    buffer_load_dwordx4 v[120:123], v84, s[20:23], s39 offen sc1
    s_add_u32 s39, s39, 0x10000
    s_waitcnt vmcnt(10) lgkmcnt(4)
    v_mfma_f32_32x32x16_bf16 v[20:35], v[56:59], v[124:127], v[20:35]
    ds_read_b64_tr_b16 v[52:53], v77 offset:49152
    ds_read_b64_tr_b16 v[54:55], v77 offset:50176
    s_waitcnt vmcnt(9) lgkmcnt(4)
    v_mfma_f32_32x32x16_bf16 v[20:35], v[60:63], v[36:39], v[20:35]
    ds_read_b64_tr_b16 v[56:57], v77 offset:51200
    ds_read_b64_tr_b16 v[58:59], v77 offset:52224
    s_waitcnt vmcnt(8) lgkmcnt(4)
    v_mfma_f32_32x32x16_bf16 v[20:35], v[64:67], v[40:43], v[20:35]
    ds_read_b64_tr_b16 v[60:61], v77 offset:53248
    ds_read_b64_tr_b16 v[62:63], v77 offset:54272
    s_waitcnt vmcnt(7) lgkmcnt(4)
    v_mfma_f32_32x32x16_bf16 v[20:35], v[52:55], v[44:47], v[20:35]
    ds_read_b64_tr_b16 v[64:65], v77 offset:55296
    ds_read_b64_tr_b16 v[66:67], v77 offset:56320
    s_waitcnt vmcnt(6) lgkmcnt(4)
    v_mfma_f32_32x32x16_bf16 v[20:35], v[56:59], v[48:51], v[20:35]
    ds_read_b64_tr_b16 v[52:53], v77 offset:57344
    ds_read_b64_tr_b16 v[54:55], v77 offset:58368
    s_waitcnt vmcnt(5) lgkmcnt(4)
    v_mfma_f32_32x32x16_bf16 v[20:35], v[60:63], v[92:95], v[20:35]
    ds_read_b64_tr_b16 v[56:57], v77 offset:59392
    ds_read_b64_tr_b16 v[58:59], v77 offset:60416
    s_waitcnt vmcnt(4) lgkmcnt(4)
    v_mfma_f32_32x32x16_bf16 v[20:35], v[64:67], v[96:99], v[20:35]
    ds_read_b64_tr_b16 v[60:61], v77 offset:61440
    ds_read_b64_tr_b16 v[62:63], v77 offset:62464
    s_waitcnt vmcnt(3) lgkmcnt(4)
    v_mfma_f32_32x32x16_bf16 v[20:35], v[52:55], v[100:103], v[20:35]
    ds_read_b64_tr_b16 v[64:65], v77 offset:63488
    ds_read_b64_tr_b16 v[66:67], v77 offset:64512
    s_waitcnt vmcnt(2) lgkmcnt(4)
    v_mfma_f32_32x32x16_bf16 v[20:35], v[56:59], v[104:107], v[20:35]
    s_waitcnt vmcnt(1) lgkmcnt(2)
    v_mfma_f32_32x32x16_bf16 v[20:35], v[60:63], v[116:119], v[20:35]
    s_waitcnt vmcnt(0) lgkmcnt(0)
    v_mfma_f32_32x32x16_bf16 v[20:35], v[64:67], v[120:123], v[20:35]
    s_nop 7
    s_nop 3
    v_fmac_f32 v4, v20, v89
    v_fmac_f32 v5, v21, v89
    v_cvt_pk_bf16_f32 v108, v4, v5
    v_fmac_f32 v6, v22, v89
    v_fmac_f32 v7, v23, v89
    v_cvt_pk_bf16_f32 v109, v6, v7
    v_fmac_f32 v8, v24, v89
    v_fmac_f32 v9, v25, v89
    v_cvt_pk_bf16_f32 v110, v8, v9
    v_fmac_f32 v10, v26, v89
    v_fmac_f32 v11, v27, v89
    v_cvt_pk_bf16_f32 v111, v10, v11
    v_fmac_f32 v12, v28, v89
    v_fmac_f32 v13, v29, v89
    v_cvt_pk_bf16_f32 v112, v12, v13
    v_fmac_f32 v14, v30, v89
    v_fmac_f32 v15, v31, v89
    v_cvt_pk_bf16_f32 v113, v14, v15
    v_fmac_f32 v16, v32, v89
    v_fmac_f32 v17, v33, v89
    v_cvt_pk_bf16_f32 v114, v16, v17
    v_fmac_f32 v18, v34, v89
    v_fmac_f32 v19, v35, v89
    v_cvt_pk_bf16_f32 v115, v18, v19
    buffer_store_dwordx2 v[108:109], v85, s[12:15], 0 offen offset:0
    buffer_store_dwordx2 v[110:111], v85, s[12:15], 0 offen offset:16
    buffer_store_dwordx2 v[112:113], v85, s[12:15], 0 offen offset:32
    buffer_store_dwordx2 v[114:115], v85, s[12:15], 0 offen offset:48
    s_branch L_mid_kernel_fin
L_mid_kernel_C_ld:
    s_mul_i32 s28, s82, 2048
    s_mul_i32 s29, s82, 2048
    s_add_u32 s29, s29, 8192
    v_mul_u32_u24 v78, 2, v3
    v_and_b32 v79, 1, v78
    v_lshrrev_b32 v78, 1, v78
    v_lshlrev_b32 v68, 4, v1
    v_lshl_add_u32 v68, v79, 10, v68
    v_lshl_add_u32 v68, v78, 16, v68
    s_lshl_b32 s30, s32, 5
    v_add_u32 v68, s30, v68
    v_mul_u32_u24 v78, 2, v3
    v_add_u32 v78, 1, v78
    v_and_b32 v79, 1, v78
    v_lshrrev_b32 v78, 1, v78
    v_lshlrev_b32 v69, 4, v1
    v_lshl_add_u32 v69, v79, 10, v69
    v_lshl_add_u32 v69, v78, 16, v69
    s_lshl_b32 s30, s32, 5
    v_add_u32 v69, s30, v69
    v_mul_u32_u24 v78, 2, v3
    v_and_b32 v79, 1, v78
    v_lshrrev_b32 v78, 1, v78
    v_lshlrev_b32 v72, 4, v1
    v_lshl_add_u32 v72, v79, 10, v72
    v_lshl_add_u32 v72, v78, 16, v72
    s_lshl_b32 s30, s32, 5
    v_add_u32 v72, s30, v72
    v_mul_u32_u24 v78, 2, v3
    v_add_u32 v78, 1, v78
    v_and_b32 v79, 1, v78
    v_lshrrev_b32 v78, 1, v78
    v_lshlrev_b32 v73, 4, v1
    v_lshl_add_u32 v73, v79, 10, v73
    v_lshl_add_u32 v73, v78, 16, v73
    s_lshl_b32 s30, s32, 5
    v_add_u32 v73, s30, v73
    v_lshrrev_b32 v78, 3, v1
    v_mul_u32_u24 v79, 16, v3
    v_add_u32 v78, v78, v79
    v_and_b32 v80, 7, v1
    v_lshrrev_b32 v79, 4, v1
    v_and_b32 v79, 1, v79
    v_lshlrev_b32 v79, 2, v79
    v_xor_b32 v80, v80, v79
    v_lshlrev_b32 v80, 4, v80
    s_lshl_b32 s30, s33, 1
    v_add_u32 v80, s30, v80
    s_mov_b32 s30, 1024
    v_mul_lo_u32 v83, v78, s30
    v_add_u32 v70, v83, v80
    v_add_u32 v71, v83, v80
    v_add_u32 v71, 0x2000, v71
    s_mov_b32 s30, 1024
    v_mul_lo_u32 v83, v78, s30
    v_add_u32 v74, v83, v80
    v_add_u32 v75, v83, v80
    v_add_u32 v75, 0x2000, v75
    v_subrev_u32 v69, 1024, v69
    v_subrev_u32 v73, 1024, v73
    v_subrev_u32 v71, 1024, v71
    v_subrev_u32 v75, 1024, v75
    v_lshlrev_b32 v87, 2, v1
    s_lshr_b32 s83, s70, 1
    s_lshl_b32 s83, s83, 7
    s_lshr_b32 s39, s70, 2
    s_lshl_b32 s39, s39, 7
    s_add_u32 s39, s39, 2048
    s_mul_i32 s31, s68, 0x10000
    s_add_u32 m0, s29, 0x0
    s_nop 0
    buffer_load_dwordx4 v70, s[8:11], s31 offen offset:0 lds
    buffer_load_dwordx4 v71, s[8:11], s31 offen offset:1024 lds
    s_add_u32 s31, s31, 0x10000
    s_cmp_eq_u32 s31, 0x1c0000
    s_cselect_b32 s31, 0x0, s31
    s_add_u32 m0, s29, 0x4000
    s_nop 0
    buffer_load_dwordx4 v70, s[8:11], s31 offen offset:0 lds
    buffer_load_dwordx4 v71, s[8:11], s31 offen offset:1024 lds
    s_add_u32 s31, s31, 0x10000
    s_cmp_eq_u32 s31, 0x1c0000
    s_cselect_b32 s31, 0x0, s31
    s_add_u32 m0, s29, 0x8000
    s_nop 0
    buffer_load_dwordx4 v70, s[8:11], s31 offen offset:0 lds
    buffer_load_dwordx4 v71, s[8:11], s31 offen offset:1024 lds
    s_add_u32 s31, s31, 0x10000
    s_cmp_eq_u32 s31, 0x1c0000
    s_cselect_b32 s31, 0x0, s31
    s_add_u32 m0, s29, 0xc000
    s_nop 0
    buffer_load_dwordx4 v70, s[8:11], s31 offen offset:0 lds
    buffer_load_dwordx4 v71, s[8:11], s31 offen offset:1024 lds
    s_cmp_lg_u32 s34, 4
    s_cbranch_scc1 L_mid_kernel_ps_9
    s_mov_b32 s66, 0x3fff
    s_mov_b32 s67, 0
    s_mov_b32 s65, 0
    s_mov_b64 exec, s[66:67]
L_mid_kernel_pl_7:
    buffer_load_dword v88, v87, s[72:75], s83 offen sc1
    s_waitcnt vmcnt(0)
    v_cmp_ne_u32 vcc, 0, v88
    s_add_u32 s65, s65, 1
    s_cmp_eq_u64 vcc, s[66:67]
    s_cbranch_scc1 L_mid_kernel_pd_8
    s_sleep 3
    s_cmp_lt_u32 s65, 0x100000
    s_cbranch_scc1 L_mid_kernel_pl_7
L_mid_kernel_pd_8:
    s_mov_b64 exec, -1
L_mid_kernel_ps_9:
    s_barrier
    s_mul_i32 s30, s68, 0x40000
    s_add_u32 m0, s28, 0x0
    s_nop 0
    buffer_load_dwordx4 v68, s[4:7], s30 offen offset:0 sc1 lds
    buffer_load_dwordx4 v69, s[4:7], s30 offen offset:1024 sc1 lds
    s_add_u32 s30, s30, 0x40000
    s_cmp_eq_u32 s30, 0x700000
    s_cselect_b32 s30, 0x0, s30
    s_add_u32 m0, s28, 0x4000
    s_nop 0
    buffer_load_dwordx4 v68, s[4:7], s30 offen offset:0 sc1 lds
    buffer_load_dwordx4 v69, s[4:7], s30 offen offset:1024 sc1 lds
    s_add_u32 s30, s30, 0x40000
    s_cmp_eq_u32 s30, 0x700000
    s_cselect_b32 s30, 0x0, s30
    s_add_u32 m0, s28, 0x8000
    s_nop 0
    buffer_load_dwordx4 v68, s[4:7], s30 offen offset:0 sc1 lds
    buffer_load_dwordx4 v69, s[4:7], s30 offen offset:1024 sc1 lds
    s_add_u32 s30, s30, 0x40000
    s_cmp_eq_u32 s30, 0x700000
    s_cselect_b32 s30, 0x0, s30
    s_add_u32 m0, s28, 0xc000
    s_nop 0
    buffer_load_dwordx4 v68, s[4:7], s30 offen offset:0 sc1 lds
    buffer_load_dwordx4 v69, s[4:7], s30 offen offset:1024 sc1 lds
    s_waitcnt vmcnt(6)
    s_barrier
    s_waitcnt vmcnt(4)
    s_barrier
    s_add_u32 s30, s30, 0x40000
    s_cmp_eq_u32 s30, 0x700000
    s_cselect_b32 s30, 0x0, s30
    s_add_u32 m0, s28, 0x0
    s_nop 0
    buffer_load_dwordx4 v68, s[4:7], s30 offen offset:0 sc1 lds
    buffer_load_dwordx4 v69, s[4:7], s30 offen offset:1024 sc1 lds
    s_add_u32 s31, s31, 0x10000
    s_cmp_eq_u32 s31, 0x1c0000
    s_cselect_b32 s31, 0x0, s31
    s_add_u32 m0, s29, 0x0
    s_nop 0
    buffer_load_dwordx4 v70, s[8:11], s31 offen offset:0 lds
    buffer_load_dwordx4 v71, s[8:11], s31 offen offset:1024 lds
    s_waitcnt vmcnt(6)
    s_barrier
    s_add_u32 s30, s30, 0x40000
    s_cmp_eq_u32 s30, 0x700000
    s_cselect_b32 s30, 0x0, s30
    s_add_u32 m0, s28, 0x4000
    s_nop 0
    buffer_load_dwordx4 v68, s[4:7], s30 offen offset:0 sc1 lds
    buffer_load_dwordx4 v69, s[4:7], s30 offen offset:1024 sc1 lds
    s_add_u32 s31, s31, 0x10000
    s_cmp_eq_u32 s31, 0x1c0000
    s_cselect_b32 s31, 0x0, s31
    s_add_u32 m0, s29, 0x4000
    s_nop 0
    buffer_load_dwordx4 v70, s[8:11], s31 offen offset:0 lds
    buffer_load_dwordx4 v71, s[8:11], s31 offen offset:1024 lds
    s_waitcnt vmcnt(8)
    s_barrier
    s_add_u32 s30, s30, 0x40000
    s_cmp_eq_u32 s30, 0x700000
    s_cselect_b32 s30, 0x0, s30
    s_add_u32 m0, s28, 0x8000
    s_nop 0
    buffer_load_dwordx4 v68, s[4:7], s30 offen offset:0 sc1 lds
    buffer_load_dwordx4 v69, s[4:7], s30 offen offset:1024 sc1 lds
    s_add_u32 s31, s31, 0x10000
    s_cmp_eq_u32 s31, 0x1c0000
    s_cselect_b32 s31, 0x0, s31
    s_add_u32 m0, s29, 0x8000
    s_nop 0
    buffer_load_dwordx4 v70, s[8:11], s31 offen offset:0 lds
    buffer_load_dwordx4 v71, s[8:11], s31 offen offset:1024 lds
    s_waitcnt vmcnt(8)
    s_barrier
    s_add_u32 s30, s30, 0x40000
    s_cmp_eq_u32 s30, 0x700000
    s_cselect_b32 s30, 0x0, s30
    s_add_u32 m0, s28, 0xc000
    s_nop 0
    buffer_load_dwordx4 v68, s[4:7], s30 offen offset:0 sc1 lds
    buffer_load_dwordx4 v69, s[4:7], s30 offen offset:1024 sc1 lds
    s_add_u32 s31, s31, 0x10000
    s_cmp_eq_u32 s31, 0x1c0000
    s_cselect_b32 s31, 0x0, s31
    s_add_u32 m0, s29, 0xc000
    s_nop 0
    buffer_load_dwordx4 v70, s[8:11], s31 offen offset:0 lds
    buffer_load_dwordx4 v71, s[8:11], s31 offen offset:1024 lds
    s_waitcnt vmcnt(8)
    s_barrier
    s_add_u32 s30, s30, 0x40000
    s_cmp_eq_u32 s30, 0x700000
    s_cselect_b32 s30, 0x0, s30
    s_add_u32 m0, s28, 0x0
    s_nop 0
    buffer_load_dwordx4 v68, s[4:7], s30 offen offset:0 sc1 lds
    buffer_load_dwordx4 v69, s[4:7], s30 offen offset:1024 sc1 lds
    s_add_u32 s31, s31, 0x10000
    s_cmp_eq_u32 s31, 0x1c0000
    s_cselect_b32 s31, 0x0, s31
    s_add_u32 m0, s29, 0x0
    s_nop 0
    buffer_load_dwordx4 v70, s[8:11], s31 offen offset:0 lds
    buffer_load_dwordx4 v71, s[8:11], s31 offen offset:1024 lds
    s_waitcnt vmcnt(8)
    s_barrier
    s_add_u32 s30, s30, 0x40000
    s_cmp_eq_u32 s30, 0x700000
    s_cselect_b32 s30, 0x0, s30
    s_add_u32 m0, s28, 0x4000
    s_nop 0
    buffer_load_dwordx4 v68, s[4:7], s30 offen offset:0 sc1 lds
    buffer_load_dwordx4 v69, s[4:7], s30 offen offset:1024 sc1 lds
    s_add_u32 s31, s31, 0x10000
    s_cmp_eq_u32 s31, 0x1c0000
    s_cselect_b32 s31, 0x0, s31
    s_add_u32 m0, s29, 0x4000
    s_nop 0
    buffer_load_dwordx4 v70, s[8:11], s31 offen offset:0 lds
    buffer_load_dwordx4 v71, s[8:11], s31 offen offset:1024 lds
    s_waitcnt vmcnt(8)
    s_barrier
    s_add_u32 s30, s30, 0x40000
    s_cmp_eq_u32 s30, 0x700000
    s_cselect_b32 s30, 0x0, s30
    s_add_u32 m0, s28, 0x8000
    s_nop 0
    buffer_load_dwordx4 v68, s[4:7], s30 offen offset:0 sc1 lds
    buffer_load_dwordx4 v69, s[4:7], s30 offen offset:1024 sc1 lds
    s_add_u32 s31, s31, 0x10000
    s_cmp_eq_u32 s31, 0x1c0000
    s_cselect_b32 s31, 0x0, s31
    s_add_u32 m0, s29, 0x8000
    s_nop 0
    buffer_load_dwordx4 v70, s[8:11], s31 offen offset:0 lds
    buffer_load_dwordx4 v71, s[8:11], s31 offen offset:1024 lds
    s_waitcnt vmcnt(8)
    s_barrier
    s_add_u32 s30, s30, 0x40000
    s_cmp_eq_u32 s30, 0x700000
    s_cselect_b32 s30, 0x0, s30
    s_add_u32 m0, s28, 0xc000
    s_nop 0
    buffer_load_dwordx4 v68, s[4:7], s30 offen offset:0 sc1 lds
    buffer_load_dwordx4 v69, s[4:7], s30 offen offset:1024 sc1 lds
    s_add_u32 s31, s31, 0x10000
    s_cmp_eq_u32 s31, 0x1c0000
    s_cselect_b32 s31, 0x0, s31
    s_add_u32 m0, s29, 0xc000
    s_nop 0
    buffer_load_dwordx4 v70, s[8:11], s31 offen offset:0 lds
    buffer_load_dwordx4 v71, s[8:11], s31 offen offset:1024 lds
    s_waitcnt vmcnt(8)
    s_barrier
    s_add_u32 s30, s30, 0x40000
    s_cmp_eq_u32 s30, 0x700000
    s_cselect_b32 s30, 0x0, s30
    s_add_u32 m0, s28, 0x0
    s_nop 0
    buffer_load_dwordx4 v68, s[4:7], s30 offen offset:0 sc1 lds
    buffer_load_dwordx4 v69, s[4:7], s30 offen offset:1024 sc1 lds
    s_add_u32 s31, s31, 0x10000
    s_cmp_eq_u32 s31, 0x1c0000
    s_cselect_b32 s31, 0x0, s31
    s_add_u32 m0, s29, 0x0
    s_nop 0
    buffer_load_dwordx4 v70, s[8:11], s31 offen offset:0 lds
    buffer_load_dwordx4 v71, s[8:11], s31 offen offset:1024 lds
    s_waitcnt vmcnt(8)
    s_barrier
    s_add_u32 s30, s30, 0x40000
    s_cmp_eq_u32 s30, 0x700000
    s_cselect_b32 s30, 0x0, s30
    s_add_u32 m0, s28, 0x4000
    s_nop 0
    buffer_load_dwordx4 v68, s[4:7], s30 offen offset:0 sc1 lds
    buffer_load_dwordx4 v69, s[4:7], s30 offen offset:1024 sc1 lds
    s_add_u32 s31, s31, 0x10000
    s_cmp_eq_u32 s31, 0x1c0000
    s_cselect_b32 s31, 0x0, s31
    s_add_u32 m0, s29, 0x4000
    s_nop 0
    buffer_load_dwordx4 v70, s[8:11], s31 offen offset:0 lds
    buffer_load_dwordx4 v71, s[8:11], s31 offen offset:1024 lds
    s_waitcnt vmcnt(8)
    s_barrier
    s_add_u32 s30, s30, 0x40000
    s_cmp_eq_u32 s30, 0x700000
    s_cselect_b32 s30, 0x0, s30
    s_add_u32 m0, s28, 0x8000
    s_nop 0
    buffer_load_dwordx4 v68, s[4:7], s30 offen offset:0 sc1 lds
    buffer_load_dwordx4 v69, s[4:7], s30 offen offset:1024 sc1 lds
    s_add_u32 s31, s31, 0x10000
    s_cmp_eq_u32 s31, 0x1c0000
    s_cselect_b32 s31, 0x0, s31
    s_add_u32 m0, s29, 0x8000
    s_nop 0
    buffer_load_dwordx4 v70, s[8:11], s31 offen offset:0 lds
    buffer_load_dwordx4 v71, s[8:11], s31 offen offset:1024 lds
    s_waitcnt vmcnt(8)
    s_barrier
    s_add_u32 s30, s30, 0x40000
    s_cmp_eq_u32 s30, 0x700000
    s_cselect_b32 s30, 0x0, s30
    s_add_u32 m0, s28, 0xc000
    s_nop 0
    buffer_load_dwordx4 v68, s[4:7], s30 offen offset:0 sc1 lds
    buffer_load_dwordx4 v69, s[4:7], s30 offen offset:1024 sc1 lds
    s_add_u32 s31, s31, 0x10000
    s_cmp_eq_u32 s31, 0x1c0000
    s_cselect_b32 s31, 0x0, s31
    s_add_u32 m0, s29, 0xc000
    s_nop 0
    buffer_load_dwordx4 v70, s[8:11], s31 offen offset:0 lds
    buffer_load_dwordx4 v71, s[8:11], s31 offen offset:1024 lds
    s_waitcnt vmcnt(8)
    s_barrier
    s_add_u32 s30, s30, 0x40000
    s_cmp_eq_u32 s30, 0x700000
    s_cselect_b32 s30, 0x0, s30
    s_add_u32 m0, s28, 0x0
    s_nop 0
    buffer_load_dwordx4 v68, s[4:7], s30 offen offset:0 sc1 lds
    buffer_load_dwordx4 v69, s[4:7], s30 offen offset:1024 sc1 lds
    s_add_u32 s31, s31, 0x10000
    s_cmp_eq_u32 s31, 0x1c0000
    s_cselect_b32 s31, 0x0, s31
    s_add_u32 m0, s29, 0x0
    s_nop 0
    buffer_load_dwordx4 v70, s[8:11], s31 offen offset:0 lds
    buffer_load_dwordx4 v71, s[8:11], s31 offen offset:1024 lds
    s_waitcnt vmcnt(8)
    s_barrier
    s_add_u32 s30, s30, 0x40000
    s_cmp_eq_u32 s30, 0x700000
    s_cselect_b32 s30, 0x0, s30
    s_add_u32 m0, s28, 0x4000
    s_nop 0
    buffer_load_dwordx4 v68, s[4:7], s30 offen offset:0 sc1 lds
    buffer_load_dwordx4 v69, s[4:7], s30 offen offset:1024 sc1 lds
    s_add_u32 s31, s31, 0x10000
    s_cmp_eq_u32 s31, 0x1c0000
    s_cselect_b32 s31, 0x0, s31
    s_add_u32 m0, s29, 0x4000
    s_nop 0
    buffer_load_dwordx4 v70, s[8:11], s31 offen offset:0 lds
    buffer_load_dwordx4 v71, s[8:11], s31 offen offset:1024 lds
    s_waitcnt vmcnt(8)
    s_barrier
    s_add_u32 s30, s30, 0x40000
    s_cmp_eq_u32 s30, 0x700000
    s_cselect_b32 s30, 0x0, s30
    s_add_u32 m0, s28, 0x8000
    s_nop 0
    buffer_load_dwordx4 v68, s[4:7], s30 offen offset:0 sc1 lds
    buffer_load_dwordx4 v69, s[4:7], s30 offen offset:1024 sc1 lds
    s_add_u32 s31, s31, 0x10000
    s_cmp_eq_u32 s31, 0x1c0000
    s_cselect_b32 s31, 0x0, s31
    s_add_u32 m0, s29, 0x8000
    s_nop 0
    buffer_load_dwordx4 v70, s[8:11], s31 offen offset:0 lds
    buffer_load_dwordx4 v71, s[8:11], s31 offen offset:1024 lds
    s_waitcnt vmcnt(8)
    s_barrier
    s_add_u32 s30, s30, 0x40000
    s_cmp_eq_u32 s30, 0x700000
    s_cselect_b32 s30, 0x0, s30
    s_add_u32 m0, s28, 0xc000
    s_nop 0
    buffer_load_dwordx4 v68, s[4:7], s30 offen offset:0 sc1 lds
    buffer_load_dwordx4 v69, s[4:7], s30 offen offset:1024 sc1 lds
    s_add_u32 s31, s31, 0x10000
    s_cmp_eq_u32 s31, 0x1c0000
    s_cselect_b32 s31, 0x0, s31
    s_add_u32 m0, s29, 0xc000
    s_nop 0
    buffer_load_dwordx4 v70, s[8:11], s31 offen offset:0 lds
    buffer_load_dwordx4 v71, s[8:11], s31 offen offset:1024 lds
    s_waitcnt vmcnt(8)
    s_barrier
    s_add_u32 s30, s30, 0x40000
    s_cmp_eq_u32 s30, 0x700000
    s_cselect_b32 s30, 0x0, s30
    s_add_u32 m0, s28, 0x0
    s_nop 0
    buffer_load_dwordx4 v68, s[4:7], s30 offen offset:0 sc1 lds
    buffer_load_dwordx4 v69, s[4:7], s30 offen offset:1024 sc1 lds
    s_add_u32 s31, s31, 0x10000
    s_cmp_eq_u32 s31, 0x1c0000
    s_cselect_b32 s31, 0x0, s31
    s_add_u32 m0, s29, 0x0
    s_nop 0
    buffer_load_dwordx4 v70, s[8:11], s31 offen offset:0 lds
    buffer_load_dwordx4 v71, s[8:11], s31 offen offset:1024 lds
    s_waitcnt vmcnt(8)
    s_barrier
    s_add_u32 s30, s30, 0x40000
    s_cmp_eq_u32 s30, 0x700000
    s_cselect_b32 s30, 0x0, s30
    s_add_u32 m0, s28, 0x4000
    s_nop 0
    buffer_load_dwordx4 v68, s[4:7], s30 offen offset:0 sc1 lds
    buffer_load_dwordx4 v69, s[4:7], s30 offen offset:1024 sc1 lds
    s_add_u32 s31, s31, 0x10000
    s_cmp_eq_u32 s31, 0x1c0000
    s_cselect_b32 s31, 0x0, s31
    s_add_u32 m0, s29, 0x4000
    s_nop 0
    buffer_load_dwordx4 v70, s[8:11], s31 offen offset:0 lds
    buffer_load_dwordx4 v71, s[8:11], s31 offen offset:1024 lds
    s_waitcnt vmcnt(8)
    s_barrier
    s_add_u32 s30, s30, 0x40000
    s_cmp_eq_u32 s30, 0x700000
    s_cselect_b32 s30, 0x0, s30
    s_add_u32 m0, s28, 0x8000
    s_nop 0
    buffer_load_dwordx4 v68, s[4:7], s30 offen offset:0 sc1 lds
    buffer_load_dwordx4 v69, s[4:7], s30 offen offset:1024 sc1 lds
    s_add_u32 s31, s31, 0x10000
    s_cmp_eq_u32 s31, 0x1c0000
    s_cselect_b32 s31, 0x0, s31
    s_add_u32 m0, s29, 0x8000
    s_nop 0
    buffer_load_dwordx4 v70, s[8:11], s31 offen offset:0 lds
    buffer_load_dwordx4 v71, s[8:11], s31 offen offset:1024 lds
    s_waitcnt vmcnt(8)
    s_barrier
    s_add_u32 s30, s30, 0x40000
    s_cmp_eq_u32 s30, 0x700000
    s_cselect_b32 s30, 0x0, s30
    s_add_u32 m0, s28, 0xc000
    s_nop 0
    buffer_load_dwordx4 v68, s[4:7], s30 offen offset:0 sc1 lds
    buffer_load_dwordx4 v69, s[4:7], s30 offen offset:1024 sc1 lds
    s_add_u32 s31, s31, 0x10000
    s_cmp_eq_u32 s31, 0x1c0000
    s_cselect_b32 s31, 0x0, s31
    s_add_u32 m0, s29, 0xc000
    s_nop 0
    buffer_load_dwordx4 v70, s[8:11], s31 offen offset:0 lds
    buffer_load_dwordx4 v71, s[8:11], s31 offen offset:1024 lds
    s_waitcnt vmcnt(8)
    s_barrier
    s_add_u32 s30, s30, 0x40000
    s_cmp_eq_u32 s30, 0x700000
    s_cselect_b32 s30, 0x0, s30
    s_add_u32 m0, s28, 0x0
    s_nop 0
    buffer_load_dwordx4 v68, s[4:7], s30 offen offset:0 sc1 lds
    buffer_load_dwordx4 v69, s[4:7], s30 offen offset:1024 sc1 lds
    s_add_u32 s31, s31, 0x10000
    s_cmp_eq_u32 s31, 0x1c0000
    s_cselect_b32 s31, 0x0, s31
    s_add_u32 m0, s29, 0x0
    s_nop 0
    buffer_load_dwordx4 v70, s[8:11], s31 offen offset:0 lds
    buffer_load_dwordx4 v71, s[8:11], s31 offen offset:1024 lds
    s_waitcnt vmcnt(8)
    s_barrier
    s_add_u32 s30, s30, 0x40000
    s_cmp_eq_u32 s30, 0x700000
    s_cselect_b32 s30, 0x0, s30
    s_add_u32 m0, s28, 0x4000
    s_nop 0
    buffer_load_dwordx4 v68, s[4:7], s30 offen offset:0 sc1 lds
    buffer_load_dwordx4 v69, s[4:7], s30 offen offset:1024 sc1 lds
    s_add_u32 s31, s31, 0x10000
    s_cmp_eq_u32 s31, 0x1c0000
    s_cselect_b32 s31, 0x0, s31
    s_add_u32 m0, s29, 0x4000
    s_nop 0
    buffer_load_dwordx4 v70, s[8:11], s31 offen offset:0 lds
    buffer_load_dwordx4 v71, s[8:11], s31 offen offset:1024 lds
    s_waitcnt vmcnt(8)
    s_barrier
    s_add_u32 s30, s30, 0x40000
    s_cmp_eq_u32 s30, 0x700000
    s_cselect_b32 s30, 0x0, s30
    s_add_u32 m0, s28, 0x8000
    s_nop 0
    buffer_load_dwordx4 v68, s[4:7], s30 offen offset:0 sc1 lds
    buffer_load_dwordx4 v69, s[4:7], s30 offen offset:1024 sc1 lds
    s_add_u32 s31, s31, 0x10000
    s_cmp_eq_u32 s31, 0x1c0000
    s_cselect_b32 s31, 0x0, s31
    s_add_u32 m0, s29, 0x8000
    s_nop 0
    buffer_load_dwordx4 v70, s[8:11], s31 offen offset:0 lds
    buffer_load_dwordx4 v71, s[8:11], s31 offen offset:1024 lds
    s_waitcnt vmcnt(8)
    s_barrier
    s_add_u32 s30, s30, 0x40000
    s_cmp_eq_u32 s30, 0x700000
    s_cselect_b32 s30, 0x0, s30
    s_add_u32 m0, s28, 0xc000
    s_nop 0
    buffer_load_dwordx4 v68, s[4:7], s30 offen offset:0 sc1 lds
    buffer_load_dwordx4 v69, s[4:7], s30 offen offset:1024 sc1 lds
    s_add_u32 s31, s31, 0x10000
    s_cmp_eq_u32 s31, 0x1c0000
    s_cselect_b32 s31, 0x0, s31
    s_add_u32 m0, s29, 0xc000
    s_nop 0
    buffer_load_dwordx4 v70, s[8:11], s31 offen offset:0 lds
    buffer_load_dwordx4 v71, s[8:11], s31 offen offset:1024 lds
    s_waitcnt vmcnt(8)
    s_barrier
    s_waitcnt vmcnt(4)
    s_barrier
    s_waitcnt vmcnt(0)
    s_barrier
    s_sub_u32 s29, s29, 8192
    s_mov_b32 s31, 0
    s_add_u32 m0, s29, 0
    s_nop 0
    buffer_load_dwordx4 v74, s[24:27], s31 offen offset:0 lds
    buffer_load_dwordx4 v75, s[24:27], s31 offen offset:1024 lds
    s_mov_b32 s31, 65536
    s_add_u32 m0, s29, 8192
    s_nop 0
    buffer_load_dwordx4 v74, s[24:27], s31 offen offset:0 lds
    buffer_load_dwordx4 v75, s[24:27], s31 offen offset:1024 lds
    s_mov_b32 s31, 131072
    s_add_u32 m0, s29, 16384
    s_nop 0
    buffer_load_dwordx4 v74, s[24:27], s31 offen offset:0 lds
    buffer_load_dwordx4 v75, s[24:27], s31 offen offset:1024 lds
    s_mov_b32 s31, 196608
    s_add_u32 m0, s29, 24576
    s_nop 0
    buffer_load_dwordx4 v74, s[24:27], s31 offen offset:0 lds
    buffer_load_dwordx4 v75, s[24:27], s31 offen offset:1024 lds
    s_mov_b32 s31, 262144
    s_add_u32 m0, s29, 32768
    s_nop 0
    buffer_load_dwordx4 v74, s[24:27], s31 offen offset:0 lds
    buffer_load_dwordx4 v75, s[24:27], s31 offen offset:1024 lds
    s_mov_b32 s31, 327680
    s_add_u32 m0, s29, 40960
    s_nop 0
    buffer_load_dwordx4 v74, s[24:27], s31 offen offset:0 lds
    buffer_load_dwordx4 v75, s[24:27], s31 offen offset:1024 lds
    s_barrier
    s_mov_b32 s31, 393216
    s_add_u32 m0, s29, 49152
    s_nop 0
    buffer_load_dwordx4 v74, s[24:27], s31 offen offset:0 lds
    buffer_load_dwordx4 v75, s[24:27], s31 offen offset:1024 lds
    s_mov_b32 s31, 458752
    s_add_u32 m0, s29, 57344
    s_nop 0
    buffer_load_dwordx4 v74, s[24:27], s31 offen offset:0 lds
    buffer_load_dwordx4 v75, s[24:27], s31 offen offset:1024 lds
    s_cmp_lg_u32 s34, 4
    s_cbranch_scc1 L_mid_kernel_ps_12
    s_mov_b32 s66, 0xffffffff
    s_mov_b32 s67, 0
    s_mov_b32 s65, 0
    s_mov_b64 exec, s[66:67]
L_mid_kernel_pl_10:
    buffer_load_dword v88, v87, s[72:75], s39 offen sc1
    s_waitcnt vmcnt(0)
    v_cmp_ne_u32 vcc, 0, v88
    s_add_u32 s65, s65, 1
    s_cmp_eq_u64 vcc, s[66:67]
    s_cbranch_scc1 L_mid_kernel_pd_11
    s_sleep 3
    s_cmp_lt_u32 s65, 0x100000
    s_cbranch_scc1 L_mid_kernel_pl_10
L_mid_kernel_pd_11:
    s_mov_b64 exec, -1
L_mid_kernel_ps_12:
    s_setprio 3
    s_waitcnt vmcnt(0)
    s_barrier
    s_branch L_mid_kernel_fin
L_mid_attn:
    s_setprio 3
    s_lshl_b32 s37, s35, 2
    s_lshr_b32 s38, s36, 3
    s_add_u32 s70, s37, s38
    s_and_b32 s71, s36, 7
    v_lshlrev_b32 v105, 4, v1
    v_lshlrev_b32 v109, 4, v1
    v_add_u32 v106, 8192, v105
    s_lshl_b32 s72, s70, 16
    s_lshl_b32 s73, s34, 10
    s_waitcnt lgkmcnt(0)
    s_add_u32 s4, s62, 0x200000
    s_addc_u32 s5, s63, 0
    s_mov_b32 s6, 0x200000
    s_mov_b32 s7, 0x20000
    s_add_u32 s8, s62, 0x400000
    s_addc_u32 s9, s63, 0
    s_mov_b32 s10, 0x200000
    s_mov_b32 s11, 0x20000
    s_mov_b32 s12, s62
    s_mov_b32 s13, s63
    s_mov_b32 s14, 0x200000
    s_mov_b32 s15, 0x20000
    s_add_u32 s16, s62, 0x1304000
    s_addc_u32 s17, s63, 0
    s_mov_b32 s18, 0x1000
    s_mov_b32 s19, 0x20000
    s_add_u32 s20, s62, 0xa00000
    s_addc_u32 s21, s63, 0
    s_mov_b32 s22, 0x200000
    s_mov_b32 s23, 0x20000
    s_add_u32 s74, s72, s73
    s_mov_b32 s75, s73
    s_lshl_b32 s37, s71, 13
    s_add_u32 s37, s37, s72
    s_add_u32 s37, s37, s73
    buffer_load_dwordx4 v[4:7], v109, s[12:15], s37 offen
    v_and_b32 v110, 31, v1
    v_lshlrev_b32 v110, 7, v110
    s_lshl_b32 s38, s70, 2
    buffer_load_dword v112, v110, s[16:19], s38 offen
    s_mov_b32 m0, s75
    s_nop 0
    buffer_load_dwordx4 v109, s[4:7], s74 offen lds
    s_add_u32 m0, s75, 32768
    s_nop 0
    buffer_load_dwordx4 v109, s[8:11], s74 offen lds
    s_add_u32 s74, s74, 8192
    s_add_u32 s75, s75, 8192
    s_and_b32 s75, s75, 32767
    s_mov_b32 m0, s75
    s_nop 0
    buffer_load_dwordx4 v109, s[4:7], s74 offen lds
    s_add_u32 m0, s75, 32768
    s_nop 0
    buffer_load_dwordx4 v109, s[8:11], s74 offen lds
    s_add_u32 s74, s74, 8192
    s_add_u32 s75, s75, 8192
    s_and_b32 s75, s75, 32767
    v_lshrrev_b32 v110, 5, v1
    v_and_b32 v111, 15, v1
    v_lshlrev_b32 v108, 4, v111
    v_lshl_add_u32 v108, v110, 8, v108
    v_add_u32 v107, 32768, v108
    v_mov_b32 v88, 0x3f803f80
    v_mov_b32 v89, 0x3f803f80
    v_mov_b32 v90, 0x3f803f80
    v_mov_b32 v91, 0x3f803f80
    v_mov_b32 v92, 0x3f803f80
    v_mov_b32 v93, 0x3f803f80
    v_mov_b32 v94, 0x3f803f80
    v_mov_b32 v95, 0x3f803f80
    v_mov_b32 v96, 0x3f803f80
    v_mov_b32 v97, 0x3f803f80
    v_mov_b32 v98, 0x3f803f80
    v_mov_b32 v99, 0x3f803f80
    v_mov_b32 v100, 0x3f803f80
    v_mov_b32 v101, 0x3f803f80
    v_mov_b32 v102, 0x3f803f80
    v_mov_b32 v103, 0x3f803f80
    v_mov_b32 v72, 0
    v_mov_b32 v73, 0
    v_mov_b32 v74, 0
    v_mov_b32 v75, 0
    v_mov_b32 v76, 0
    v_mov_b32 v77, 0
    v_mov_b32 v78, 0
    v_mov_b32 v79, 0
    v_mov_b32 v56, 0
    v_mov_b32 v57, 0
    v_mov_b32 v58, 0
    v_mov_b32 v59, 0
    v_mov_b32 v60, 0
    v_mov_b32 v61, 0
    v_mov_b32 v62, 0
    v_mov_b32 v63, 0
    v_mov_b32 v64, 0
    v_mov_b32 v65, 0
    v_mov_b32 v66, 0
    v_mov_b32 v67, 0
    v_mov_b32 v68, 0
    v_mov_b32 v69, 0
    v_mov_b32 v70, 0
    v_mov_b32 v71, 0
    s_mov_b32 s76, 0xffff
    s_mov_b32 s77, 0xffff
    v_mov_b32 v110, 0
    s_waitcnt vmcnt(4)
    v_dot2c_f32_bf16 v110, v4, v4
    v_dot2c_f32_bf16 v110, v5, v5
    v_dot2c_f32_bf16 v110, v6, v6
    v_dot2c_f32_bf16 v110, v7, v7
    s_nop 1
    v_max_f32_dpp v112, v112, v112 row_shr:1 row_mask:0xf bank_mask:0xf
    s_nop 1
    v_max_f32_dpp v112, v112, v112 row_shr:2 row_mask:0xf bank_mask:0xf
    s_nop 1
    v_max_f32_dpp v112, v112, v112 row_shr:4 row_mask:0xf bank_mask:0xf
    s_nop 1
    v_max_f32_dpp v112, v112, v112 row_shr:8 row_mask:0xf bank_mask:0xf
    s_nop 1
    v_max_f32_dpp v112, v112, v112 row_bcast:15 row_mask:0xa bank_mask:0xf
    s_nop 1
    v_max_f32_dpp v112, v112, v112 row_bcast:31 row_mask:0xc bank_mask:0xf
    v_mov_b32 v111, v110
    s_nop 1
    v_readlane_b32 s78, v112, 63
    v_permlane32_swap_b32 v110, v111
    s_nop 1
    v_add_f32 v110, v110, v111
    v_mul_f32 v110, s78, v110
    v_sqrt_f32 v110, v110
    s_nop 0
    v_mul_f32 v110, 0xbf8147ae, v110
    v_mov_b32 v8, v110
    v_mov_b32 v9, v110
    v_mov_b32 v10, v110
    v_mov_b32 v11, v110
    v_mov_b32 v12, v110
    v_mov_b32 v13, v110
    v_mov_b32 v14, v110
    v_mov_b32 v15, v110
    v_mov_b32 v16, v110
    v_mov_b32 v17, v110
    v_mov_b32 v18, v110
    v_mov_b32 v19, v110
    v_mov_b32 v20, v110
    v_mov_b32 v21, v110
    v_mov_b32 v22, v110
    v_mov_b32 v23, v110
    s_waitcnt vmcnt(2)
    s_barrier
    ds_read_b128 v[80:83], v105
    ds_read_b128 v[84:87], v105 offset:1024
    s_waitcnt lgkmcnt(1)
    v_mfma_f32_32x32x16_bf16 v[24:39], v[80:83], v[4:7], v[8:23]
    s_mov_b32 m0, s75
    s_nop 0
    buffer_load_dwordx4 v109, s[4:7], s74 offen lds
    s_add_u32 m0, s75, 32768
    s_nop 0
    buffer_load_dwordx4 v109, s[8:11], s74 offen lds
    s_add_u32 s74, s74, 8192
    s_add_u32 s75, s75, 8192
    s_and_b32 s75, s75, 32767
    s_mov_b32 s79, 0
    s_setprio 1
    s_nop 7
L_mid_a_loop:
    s_waitcnt lgkmcnt(0)
    v_mfma_f32_32x32x16_bf16 v[56:71], v[96:99], v[72:75], v[56:71]
    ds_read_b128 v[80:83], v105 offset:2048
    s_mov_b64 exec, s[76:77]
    ds_read_b128 v[88:91], v107 offset:0
    ds_read_b128 v[92:95], v107 offset:512
    s_mov_b64 exec, -1
    v_exp_f32 v24, v24
    v_exp_f32 v25, v25
    v_exp_f32 v26, v26
    v_cvt_pk_bf16_f32 v72, v24, v25
    v_exp_f32 v27, v27
    v_exp_f32 v28, v28
    v_cvt_pk_bf16_f32 v73, v26, v27
    v_mfma_f32_32x32x16_bf16 v[40:55], v[84:87], v[4:7], v[8:23]
    v_exp_f32 v29, v29
    v_exp_f32 v30, v30
    v_cvt_pk_bf16_f32 v74, v28, v29
    v_exp_f32 v31, v31
    v_exp_f32 v32, v32
    v_cvt_pk_bf16_f32 v75, v30, v31
    v_exp_f32 v33, v33
    v_mfma_f32_32x32x16_bf16 v[56:71], v[100:103], v[76:79], v[56:71]
    v_exp_f32 v34, v34
    v_cvt_pk_bf16_f32 v76, v32, v33
    v_exp_f32 v35, v35
    v_exp_f32 v36, v36
    v_cvt_pk_bf16_f32 v77, v34, v35
    v_exp_f32 v37, v37
    v_exp_f32 v38, v38
    v_cvt_pk_bf16_f32 v78, v36, v37
    v_exp_f32 v39, v39
    s_nop 0
    v_cvt_pk_bf16_f32 v79, v38, v39
    s_waitcnt lgkmcnt(0)
    v_mfma_f32_32x32x16_bf16 v[56:71], v[88:91], v[72:75], v[56:71]
    ds_read_b128 v[84:87], v105 offset:3072
    s_mov_b64 exec, s[76:77]
    ds_read_b128 v[96:99], v107 offset:1024
    ds_read_b128 v[100:103], v107 offset:1536
    s_mov_b64 exec, -1
    v_exp_f32 v40, v40
    v_exp_f32 v41, v41
    v_exp_f32 v42, v42
    v_cvt_pk_bf16_f32 v72, v40, v41
    v_exp_f32 v43, v43
    v_exp_f32 v44, v44
    v_cvt_pk_bf16_f32 v73, v42, v43
    v_mfma_f32_32x32x16_bf16 v[24:39], v[80:83], v[4:7], v[8:23]
    v_exp_f32 v45, v45
    v_exp_f32 v46, v46
    v_cvt_pk_bf16_f32 v74, v44, v45
    v_exp_f32 v47, v47
    v_exp_f32 v48, v48
    v_cvt_pk_bf16_f32 v75, v46, v47
    v_exp_f32 v49, v49
    v_mfma_f32_32x32x16_bf16 v[56:71], v[92:95], v[76:79], v[56:71]
    v_exp_f32 v50, v50
    v_cvt_pk_bf16_f32 v76, v48, v49
    v_exp_f32 v51, v51
    v_exp_f32 v52, v52
    v_cvt_pk_bf16_f32 v77, v50, v51
    v_exp_f32 v53, v53
    v_exp_f32 v54, v54
    v_cvt_pk_bf16_f32 v78, v52, v53
    v_exp_f32 v55, v55
    s_nop 0
    v_cvt_pk_bf16_f32 v79, v54, v55
    s_waitcnt lgkmcnt(0)
    v_mfma_f32_32x32x16_bf16 v[56:71], v[96:99], v[72:75], v[56:71]
    ds_read_b128 v[80:83], v105 offset:4096
    s_mov_b64 exec, s[76:77]
    ds_read_b128 v[88:91], v107 offset:2048
    ds_read_b128 v[92:95], v107 offset:2560
    s_mov_b64 exec, -1
    v_exp_f32 v24, v24
    v_exp_f32 v25, v25
    v_exp_f32 v26, v26
    v_cvt_pk_bf16_f32 v72, v24, v25
    v_exp_f32 v27, v27
    v_exp_f32 v28, v28
    v_cvt_pk_bf16_f32 v73, v26, v27
    v_mfma_f32_32x32x16_bf16 v[40:55], v[84:87], v[4:7], v[8:23]
    v_exp_f32 v29, v29
    v_exp_f32 v30, v30
    v_cvt_pk_bf16_f32 v74, v28, v29
    v_exp_f32 v31, v31
    v_exp_f32 v32, v32
    v_cvt_pk_bf16_f32 v75, v30, v31
    v_exp_f32 v33, v33
    v_mfma_f32_32x32x16_bf16 v[56:71], v[100:103], v[76:79], v[56:71]
    v_exp_f32 v34, v34
    v_cvt_pk_bf16_f32 v76, v32, v33
    v_exp_f32 v35, v35
    v_exp_f32 v36, v36
    v_cvt_pk_bf16_f32 v77, v34, v35
    v_exp_f32 v37, v37
    v_exp_f32 v38, v38
    v_cvt_pk_bf16_f32 v78, v36, v37
    v_exp_f32 v39, v39
    s_nop 0
    v_cvt_pk_bf16_f32 v79, v38, v39
    s_waitcnt lgkmcnt(0)
    v_mfma_f32_32x32x16_bf16 v[56:71], v[88:91], v[72:75], v[56:71]
    ds_read_b128 v[84:87], v105 offset:5120
    s_mov_b64 exec, s[76:77]
    ds_read_b128 v[96:99], v107 offset:3072
    ds_read_b128 v[100:103], v107 offset:3584
    s_mov_b64 exec, -1
    v_exp_f32 v40, v40
    v_exp_f32 v41, v41
    v_exp_f32 v42, v42
    v_cvt_pk_bf16_f32 v72, v40, v41
    v_exp_f32 v43, v43
    v_exp_f32 v44, v44
    v_cvt_pk_bf16_f32 v73, v42, v43
    v_mfma_f32_32x32x16_bf16 v[24:39], v[80:83], v[4:7], v[8:23]
    v_exp_f32 v45, v45
    v_exp_f32 v46, v46
    v_cvt_pk_bf16_f32 v74, v44, v45
    v_exp_f32 v47, v47
    v_exp_f32 v48, v48
    v_cvt_pk_bf16_f32 v75, v46, v47
    v_exp_f32 v49, v49
    v_mfma_f32_32x32x16_bf16 v[56:71], v[92:95], v[76:79], v[56:71]
    v_exp_f32 v50, v50
    v_cvt_pk_bf16_f32 v76, v48, v49
    v_exp_f32 v51, v51
    v_exp_f32 v52, v52
    v_cvt_pk_bf16_f32 v77, v50, v51
    v_exp_f32 v53, v53
    v_exp_f32 v54, v54
    v_cvt_pk_bf16_f32 v78, v52, v53
    v_exp_f32 v55, v55
    s_nop 0
    v_cvt_pk_bf16_f32 v79, v54, v55
    s_waitcnt lgkmcnt(0)
    v_mfma_f32_32x32x16_bf16 v[56:71], v[96:99], v[72:75], v[56:71]
    ds_read_b128 v[80:83], v105 offset:6144
    s_mov_b64 exec, s[76:77]
    ds_read_b128 v[88:91], v107 offset:4096
    ds_read_b128 v[92:95], v107 offset:4608
    s_mov_b64 exec, -1
    v_exp_f32 v24, v24
    v_exp_f32 v25, v25
    v_exp_f32 v26, v26
    v_cvt_pk_bf16_f32 v72, v24, v25
    v_exp_f32 v27, v27
    v_exp_f32 v28, v28
    v_cvt_pk_bf16_f32 v73, v26, v27
    v_mfma_f32_32x32x16_bf16 v[40:55], v[84:87], v[4:7], v[8:23]
    v_exp_f32 v29, v29
    v_exp_f32 v30, v30
    v_cvt_pk_bf16_f32 v74, v28, v29
    v_exp_f32 v31, v31
    v_exp_f32 v32, v32
    v_cvt_pk_bf16_f32 v75, v30, v31
    v_exp_f32 v33, v33
    v_mfma_f32_32x32x16_bf16 v[56:71], v[100:103], v[76:79], v[56:71]
    v_exp_f32 v34, v34
    v_cvt_pk_bf16_f32 v76, v32, v33
    v_exp_f32 v35, v35
    v_exp_f32 v36, v36
    v_cvt_pk_bf16_f32 v77, v34, v35
    v_exp_f32 v37, v37
    v_exp_f32 v38, v38
    v_cvt_pk_bf16_f32 v78, v36, v37
    v_exp_f32 v39, v39
    s_nop 0
    v_cvt_pk_bf16_f32 v79, v38, v39
    s_waitcnt vmcnt(0)
    s_barrier
    s_cmp_lt_u32 s79, 5
    s_cbranch_scc1 L_mid_a_refill
    s_setprio 3
L_mid_a_refilled:
    s_waitcnt lgkmcnt(0)
    v_mfma_f32_32x32x16_bf16 v[56:71], v[88:91], v[72:75], v[56:71]
    ds_read_b128 v[84:87], v105 offset:7168
    s_mov_b64 exec, s[76:77]
    ds_read_b128 v[96:99], v107 offset:5120
    ds_read_b128 v[100:103], v107 offset:5632
    s_mov_b64 exec, -1
    v_exp_f32 v40, v40
    v_exp_f32 v41, v41
    v_exp_f32 v42, v42
    v_cvt_pk_bf16_f32 v72, v40, v41
    v_exp_f32 v43, v43
    v_exp_f32 v44, v44
    v_cvt_pk_bf16_f32 v73, v42, v43
    v_mfma_f32_32x32x16_bf16 v[24:39], v[80:83], v[4:7], v[8:23]
    v_exp_f32 v45, v45
    v_exp_f32 v46, v46
    v_cvt_pk_bf16_f32 v74, v44, v45
    v_exp_f32 v47, v47
    v_exp_f32 v48, v48
    v_cvt_pk_bf16_f32 v75, v46, v47
    v_exp_f32 v49, v49
    v_mfma_f32_32x32x16_bf16 v[56:71], v[92:95], v[76:79], v[56:71]
    v_exp_f32 v50, v50
    v_cvt_pk_bf16_f32 v76, v48, v49
    v_exp_f32 v51, v51
    v_exp_f32 v52, v52
    v_cvt_pk_bf16_f32 v77, v50, v51
    v_exp_f32 v53, v53
    v_exp_f32 v54, v54
    v_cvt_pk_bf16_f32 v78, v52, v53
    v_exp_f32 v55, v55
    s_nop 0
    v_cvt_pk_bf16_f32 v79, v54, v55
    s_waitcnt lgkmcnt(0)
    v_mfma_f32_32x32x16_bf16 v[56:71], v[96:99], v[72:75], v[56:71]
    ds_read_b128 v[80:83], v106 offset:0
    s_mov_b64 exec, s[76:77]
    ds_read_b128 v[88:91], v107 offset:6144
    ds_read_b128 v[92:95], v107 offset:6656
    s_mov_b64 exec, -1
    v_exp_f32 v24, v24
    v_exp_f32 v25, v25
    v_exp_f32 v26, v26
    v_cvt_pk_bf16_f32 v72, v24, v25
    v_exp_f32 v27, v27
    v_exp_f32 v28, v28
    v_cvt_pk_bf16_f32 v73, v26, v27
    v_mfma_f32_32x32x16_bf16 v[40:55], v[84:87], v[4:7], v[8:23]
    v_exp_f32 v29, v29
    v_exp_f32 v30, v30
    v_cvt_pk_bf16_f32 v74, v28, v29
    v_exp_f32 v31, v31
    v_exp_f32 v32, v32
    v_cvt_pk_bf16_f32 v75, v30, v31
    v_exp_f32 v33, v33
    v_mfma_f32_32x32x16_bf16 v[56:71], v[100:103], v[76:79], v[56:71]
    v_exp_f32 v34, v34
    v_cvt_pk_bf16_f32 v76, v32, v33
    v_exp_f32 v35, v35
    v_exp_f32 v36, v36
    v_cvt_pk_bf16_f32 v77, v34, v35
    v_exp_f32 v37, v37
    v_exp_f32 v38, v38
    v_cvt_pk_bf16_f32 v78, v36, v37
    v_exp_f32 v39, v39
    s_nop 0
    v_cvt_pk_bf16_f32 v79, v38, v39
    s_waitcnt lgkmcnt(0)
    v_mfma_f32_32x32x16_bf16 v[56:71], v[88:91], v[72:75], v[56:71]
    ds_read_b128 v[84:87], v106 offset:1024
    s_mov_b64 exec, s[76:77]
    ds_read_b128 v[96:99], v107 offset:7168
    ds_read_b128 v[100:103], v107 offset:7680
    s_mov_b64 exec, -1
    v_exp_f32 v40, v40
    v_exp_f32 v41, v41
    v_exp_f32 v42, v42
    v_cvt_pk_bf16_f32 v72, v40, v41
    v_exp_f32 v43, v43
    v_exp_f32 v44, v44
    v_cvt_pk_bf16_f32 v73, v42, v43
    v_mfma_f32_32x32x16_bf16 v[24:39], v[80:83], v[4:7], v[8:23]
    v_exp_f32 v45, v45
    v_exp_f32 v46, v46
    v_cvt_pk_bf16_f32 v74, v44, v45
    v_exp_f32 v47, v47
    v_exp_f32 v48, v48
    v_cvt_pk_bf16_f32 v75, v46, v47
    v_exp_f32 v49, v49
    v_mfma_f32_32x32x16_bf16 v[56:71], v[92:95], v[76:79], v[56:71]
    v_exp_f32 v50, v50
    v_cvt_pk_bf16_f32 v76, v48, v49
    v_exp_f32 v51, v51
    v_exp_f32 v52, v52
    v_cvt_pk_bf16_f32 v77, v50, v51
    v_exp_f32 v53, v53
    v_exp_f32 v54, v54
    v_cvt_pk_bf16_f32 v78, v52, v53
    v_exp_f32 v55, v55
    v_add_u32 v107, 32768, v106
    v_cvt_pk_bf16_f32 v79, v54, v55
    v_sub_u32 v107, v107, v109
    v_mov_b32 v105, v106
    v_add_u32 v107, v107, v108
    v_add_u32 v106, 8192, v106
    v_and_b32 v106, 32767, v106
    s_add_u32 s79, s79, 1
    s_cmp_lt_u32 s79, 8
    s_cbranch_scc1 L_mid_a_loop
    s_waitcnt lgkmcnt(0)
    v_mfma_f32_32x32x16_bf16 v[56:71], v[96:99], v[72:75], v[56:71]
    v_mfma_f32_32x32x16_bf16 v[56:71], v[100:103], v[76:79], v[56:71]
    s_lshl_b32 s38, s71, 13
    s_add_u32 s38, s38, s72
    s_add_u32 s38, s38, s73
    s_nop 5
    v_mov_b32 v111, 0x1f800000
    s_nop 5
    v_cmp_ngt_f32 vcc, v64, v111
    s_cbranch_vccnz L_mid_a_slow
L_mid_a_fin:
    v_rcp_f32 v110, v64
    s_nop 0
    v_mul_f32 v56, v56, v110
    v_mul_f32 v57, v57, v110
    v_mul_f32 v58, v58, v110
    v_mul_f32 v59, v59, v110
    v_mul_f32 v60, v60, v110
    v_mul_f32 v61, v61, v110
    v_mul_f32 v62, v62, v110
    v_mul_f32 v63, v63, v110
    v_cvt_pk_bf16_f32 v72, v56, v57
    v_cvt_pk_bf16_f32 v73, v58, v59
    v_cvt_pk_bf16_f32 v74, v60, v61
    v_cvt_pk_bf16_f32 v75, v62, v63
    buffer_store_dwordx4 v[72:75], v109, s[20:23], s38 offen sc1
    s_add_u32 s12, s62, 0x13a0000
    s_addc_u32 s13, s63, 0
    s_mov_b32 s14, 0x1000
    s_mov_b32 s15, 0x20000
    s_lshl_b32 s37, s71, 7
    s_lshl_b32 s38, s70, 2
    s_add_u32 s37, s37, s38
    s_add_u32 s37, s37, 2048
    v_mov_b32 v110, 0
    v_mov_b32 v111, 1
    s_waitcnt vmcnt(0)
    s_barrier
    s_cmp_lg_u32 s34, 0
    s_cbranch_scc1 L_mid_kernel_fin
    s_mov_b64 exec, 1
    buffer_store_dword v111, v110, s[12:15], s37 offen sc1
    s_mov_b64 exec, -1
    s_branch L_mid_kernel_fin
L_mid_a_refill:
    s_mov_b32 m0, s75
    s_nop 0
    buffer_load_dwordx4 v109, s[4:7], s74 offen lds
    s_add_u32 m0, s75, 32768
    s_nop 0
    buffer_load_dwordx4 v109, s[8:11], s74 offen lds
    s_add_u32 s74, s74, 8192
    s_add_u32 s75, s75, 8192
    s_and_b32 s75, s75, 32767
    s_branch L_mid_a_refilled
L_mid_a_slow:
    v_mov_b32 v110, 0xff61b1e6
    s_mov_b32 s79, 0
    s_mov_b32 s74, s72
L_mid_a_slow_max:
    buffer_load_dwordx4 v[80:83], v109, s[4:7], s74 offen
    s_waitcnt vmcnt(0)
    v_mfma_f32_32x32x16_bf16 v[24:39], v[80:83], v[4:7], 0
    s_add_u32 s74, s74, 1024
    s_nop 15
    v_max3_f32 v110, v24, v25, v110
    v_max3_f32 v110, v26, v27, v110
    v_max3_f32 v110, v28, v29, v110
    v_max3_f32 v110, v30, v31, v110
    v_max3_f32 v110, v32, v33, v110
    v_max3_f32 v110, v34, v35, v110
    v_max3_f32 v110, v36, v37, v110
    v_max3_f32 v110, v38, v39, v110
    s_add_u32 s79, s79, 1
    s_cmp_lt_u32 s79, 64
    s_cbranch_scc1 L_mid_a_slow_max
    v_mov_b32 v111, v110
    s_nop 1
    v_permlane32_swap_b32 v110, v111
    s_nop 1
    v_max_f32 v110, v110, v111
    v_sub_f32 v110, 0, v110
    v_mov_b32 v8, v110
    v_mov_b32 v56, 0
    v_mov_b32 v9, v110
    v_mov_b32 v57, 0
    v_mov_b32 v10, v110
    v_mov_b32 v58, 0
    v_mov_b32 v11, v110
    v_mov_b32 v59, 0
    v_mov_b32 v12, v110
    v_mov_b32 v60, 0
    v_mov_b32 v13, v110
    v_mov_b32 v61, 0
    v_mov_b32 v14, v110
    v_mov_b32 v62, 0
    v_mov_b32 v15, v110
    v_mov_b32 v63, 0
    v_mov_b32 v16, v110
    v_mov_b32 v64, 0
    v_mov_b32 v17, v110
    v_mov_b32 v65, 0
    v_mov_b32 v18, v110
    v_mov_b32 v66, 0
    v_mov_b32 v19, v110
    v_mov_b32 v67, 0
    v_mov_b32 v20, v110
    v_mov_b32 v68, 0
    v_mov_b32 v21, v110
    v_mov_b32 v69, 0
    v_mov_b32 v22, v110
    v_mov_b32 v70, 0
    v_mov_b32 v23, v110
    v_mov_b32 v71, 0
    s_mov_b32 s79, 0
    s_mov_b32 s74, s72
L_mid_a_slow_loop:
    buffer_load_dwordx4 v[80:83], v109, s[4:7], s74 offen
    s_mov_b64 exec, s[76:77]
    buffer_load_dwordx4 v[88:91], v108, s[8:11], s74 offen
    buffer_load_dwordx4 v[92:95], v108, s[8:11], s74 offen offset:512
    s_mov_b64 exec, -1
    s_waitcnt vmcnt(0)
    v_mfma_f32_32x32x16_bf16 v[24:39], v[80:83], v[4:7], v[8:23]
    s_add_u32 s74, s74, 1024
    s_nop 15
    v_exp_f32 v24, v24
    v_exp_f32 v25, v25
    v_exp_f32 v26, v26
    v_exp_f32 v27, v27
    v_exp_f32 v28, v28
    v_exp_f32 v29, v29
    v_exp_f32 v30, v30
    v_exp_f32 v31, v31
    v_exp_f32 v32, v32
    v_exp_f32 v33, v33
    v_exp_f32 v34, v34
    v_exp_f32 v35, v35
    v_exp_f32 v36, v36
    v_exp_f32 v37, v37
    v_exp_f32 v38, v38
    v_exp_f32 v39, v39
    s_nop 0
    v_cvt_pk_bf16_f32 v72, v24, v25
    v_cvt_pk_bf16_f32 v73, v26, v27
    v_cvt_pk_bf16_f32 v74, v28, v29
    v_cvt_pk_bf16_f32 v75, v30, v31
    v_cvt_pk_bf16_f32 v76, v32, v33
    v_cvt_pk_bf16_f32 v77, v34, v35
    v_cvt_pk_bf16_f32 v78, v36, v37
    v_cvt_pk_bf16_f32 v79, v38, v39
    s_nop 1
    v_mfma_f32_32x32x16_bf16 v[56:71], v[88:91], v[72:75], v[56:71]
    v_mfma_f32_32x32x16_bf16 v[56:71], v[92:95], v[76:79], v[56:71]
    s_add_u32 s79, s79, 1
    s_cmp_lt_u32 s79, 64
    s_cbranch_scc1 L_mid_a_slow_loop
    s_nop 15
    s_branch L_mid_a_fin
L_mid_kernel_fin:
L_mid_kernel_end:
    s_endpgm

.section .rodata,"a"
.p2align 6
.amdhsa_kernel mid_kernel
  .amdhsa_next_free_vgpr 128
  .amdhsa_next_free_sgpr 96
  .amdhsa_accum_offset 128
  .amdhsa_group_segment_fixed_size 0
  .amdhsa_kernarg_size 96
  .amdhsa_user_sgpr_count 2
  .amdhsa_user_sgpr_kernarg_segment_ptr 1
  .amdhsa_system_sgpr_workgroup_id_x 1
.end_amdhsa_kernel
```
